```python
import torch

def _softmax(x, axis=-1):
    return torch.softmax(x, dim=axis)
def _gelu(x):
    return torch.nn.functional.gelu(x, approximate="tanh")
def _silu(x):
    return torch.nn.functional.silu(x)
def _sigmoid(x):
    return torch.sigmoid(x)
def _layernorm(x, axis=-1, eps=1e-5):
    m = x.mean(dim=axis, keepdim=True)
    v = x.var(dim=axis, keepdim=True, unbiased=False)
    return (x - m) / torch.sqrt(v + eps)
def _scatter_add(tgt, idx, src, axis=0):
    return tgt.clone().index_add_(axis, idx, src)
def _segment_sum(src, seg, n):
    out = torch.zeros((n,) + src.shape[1:], dtype=src.dtype)
    return out.index_add_(0, seg, src)
def _pad(x, pw):
    flat = tuple(v for pair in reversed(pw) for v in pair)
    return torch.nn.functional.pad(x, flat)

kernel_name = 'gated_mix__ssm_conv_h3__mixer_token_mlp__prompt'

def setup_inputs():

    _w = (lambda a: (lambda t: t.to(torch.bfloat16) if t.is_floating_point() else t)(torch.as_tensor(a)))
    def _A_setup():
        B, S, D = 1, 2048, 640
        ks = 4
        return {
            "q": _w((lambda *s: torch.randn(*s, dtype=torch.bfloat16) * 0.05)(B, S, D)),
            "k": _w((lambda *s: torch.randn(*s, dtype=torch.bfloat16) * 0.4)(B, S, D)),
            "v": _w((lambda *s: torch.randn(*s, dtype=torch.bfloat16) * 0.2)(B, S, D)),
            "shift_k": _w((lambda *s: torch.randn(*s, dtype=torch.bfloat16) * 0.4)(D, ks) * 0.5),
            "ssm_k": _w((lambda *s: torch.randn(*s, dtype=torch.bfloat16) * 0.8)(D, S) * (1.0 / S ** 0.5)),
            "ssm_D": _w((lambda *s: torch.randn(*s, dtype=torch.bfloat16) * 0.2)(D)),
        }
    _A_in = _A_setup()

    def _B_setup():
        B, S, D, F = 1, 2048, 640, 1536
        return {
            "x": _w((lambda *s: torch.randn(*s, dtype=torch.bfloat16) * 0.05)(B, S, D)),
            "w1": _w((lambda *s: torch.randn(*s, dtype=torch.bfloat16) * 0.2)(S, F) * (S ** -0.5)),
            "b1": _w((lambda *s: torch.randn(*s, dtype=torch.bfloat16) * 3.2)(F) * 0.02),
            "w2": _w((lambda *s: torch.randn(*s, dtype=torch.bfloat16) * 0.05)(F, S) * (F ** -0.5)),
            "b2": _w((lambda *s: torch.randn(*s, dtype=torch.bfloat16) * 0.1)(S) * 0.02),
        }
    _B_in = _B_setup()

    return {
        "A_q": _A_in["q"],
        "A_k": _A_in["k"],
        "A_v": _A_in["v"],
        "A_shift_k": _A_in["shift_k"],
        "A_ssm_k": _A_in["ssm_k"],
        "A_ssm_D": _A_in["ssm_D"],
        "B_x": _B_in["x"],
        "B_w1": _B_in["w1"],
        "B_b1": _B_in["b1"],
        "B_w2": _B_in["w2"],
        "B_b2": _B_in["b2"],
        "gate_w": _w((lambda *s: torch.randn(*s, dtype=torch.bfloat16) * 0.05)(640) * 16.0),
    }

def reference(A_q, A_k, A_v, A_shift_k, A_ssm_k, A_ssm_D, B_x, B_w1, B_b1, B_w2, B_b2, gate_w):
    def _A_ref(q, k, v, shift_k, ssm_k, ssm_D):
        B, S, D = q.shape
        ks = shift_k.shape[-1]
        k_pad = _pad(k, ((0, 0), (ks - 1, 0), (0, 0)))
        k_shift = torch.zeros_like(k)
        for t in range(ks):
            k_shift = k_shift + k_pad[:, t:t + S, :] * shift_k[:, ks - 1 - t][None, None, :]
        kv = k_shift * v
        L = 2 * S
        kv_pad = _pad(kv, ((0, 0), (0, S), (0, 0)))
        kf_pad = _pad(ssm_k, ((0, 0), (0, S)))
        kv_f = (lambda x, axes=(-2,-1): torch.fft.rfft2(x.float(), dim=axes))(kv_pad[:, None, :, :], axes=(1, 2))
        kf_f = (lambda x, axes=(-2,-1): torch.fft.rfft2(x.float(), dim=axes))(kf_pad[:, None, :], axes=(1, 2))
        kf_f = (lambda x, *d: x.permute(*d))(kf_f, 1, 2, 0)
        y_f = kv_f * kf_f[None, :, :, :]
        y = (lambda x, s, axes=(-2,-1): torch.fft.irfft2(x, s=s, dim=axes).to(torch.bfloat16))(y_f, (1, L), axes=(1, 2))[:, 0, :S, :]
        y = y + kv * ssm_D[None, None, :]
        return q * y

    def _B_ref(x, w1, b1, w2, b2):
        B, S, D = x.shape
        h = _layernorm(x, axis=-1)
        u = torch.einsum("bsd,sf->bdf", h, w1) + b1
        u = _gelu(u)
        y = torch.einsum("bdf,fs->bds", u, w2) + b2
        return (lambda x, *d: x.permute(*d))(y, 0, 2, 1)

    x = A_q
    g = _sigmoid((x * gate_w).sum(-1, keepdims=True))
    a = _A_ref(x, A_k, A_v, A_shift_k, A_ssm_k, A_ssm_D)
    b = _B_ref(x, B_w1, B_b1, B_w2, B_b2)
    return g * a + (1 - g) * b
```

```asm
; @launch grid=(256,1,1) block=(256,1,1) lds=163840
.amdgcn_target "amdgcn-amd-amdhsa--gfx950"
.text
.globl gated_mix__ssm_conv_h3__mixer_token_mlp__prompt_kernel
.p2align 12
.fill 256, 4, 0xbf800000
.p2align 8
.type gated_mix__ssm_conv_h3__mixer_token_mlp__prompt_kernel,@function
gated_mix__ssm_conv_h3__mixer_token_mlp__prompt_kernel:
    s_load_dwordx16 s[4:19], s[0:1], 0
    s_cmp_ge_u32 s2, 256
    s_cbranch_scc1 L_end
    s_load_dwordx8 s[20:27], s[0:1], 64
    s_load_dwordx2 s[28:29], s[0:1], 96
    s_load_dwordx2 s[30:31], s[0:1], 112
    s_lshr_b32 s97, s2, 3
    s_and_b32 s96, s2, 7
    s_lshl_b32 s51, s96, 5
    s_add_u32 s51, s51, s97
    v_and_b32 v8, 31, v0
    v_lshrrev_b32 v9, 5, v0
    v_lshl_add_u32 v7, s51, 3, v9
    v_mul_u32_u24 v7, 1280, v7
    v_lshl_add_u32 v6, v8, 4, v7
    v_lshl_add_u32 v7, v8, 3, v7
    s_waitcnt lgkmcnt(0)
    global_load_dwordx4 v[64:67], v6, s[4:5]
    global_load_dwordx4 v[68:71], v6, s[4:5] offset:512
    global_load_dwordx2 v[72:73], v7, s[4:5] offset:1024
    v_lshrrev_b32 v10, 6, v0
    v_and_b32 v1, 63, v0
    v_readfirstlane_b32 s50, v10
    v_lshrrev_b32 v2, 4, v1
    v_and_b32 v3, 15, v1
    s_mul_i32 s98, s97, 52
    s_lshr_b32 s98, s98, 8
    s_mul_i32 s99, s98, 5
    s_sub_u32 s52, s97, s99
    s_lshl_b32 s58, s52, 2
    s_lshr_b32 s58, 0x64310, s58
    s_and_b32 s99, s96, 1
    s_lshl1_add_u32 s52, s52, s99
    s_lshl2_add_u32 s3, s99, s50
    s_lshr_b32 s99, s96, 1
    s_mul_i32 s53, s99, 6
    s_add_u32 s53, s53, s98
    s_cmp_lt_u32 s97, 30
    s_cselect_b32 s77, 1, 0
    s_mul_i32 s59, s50, 24576
    v_lshrrev_b32 v10, 3, v1
    v_mul_u32_u24 v10, 3072, v10
    s_mul_i32 s98, s3, 786432
    s_lshl_b32 s99, s53, 7
    s_add_u32 s98, s98, s99
    v_add_u32 v10, s98, v10
    v_and_b32 v11, 7, v1
    v_and_b32 v12, 1, v2
    v_lshlrev_b32 v12, 1, v12
    v_xor_b32 v11, v11, v12
    v_xor_b32 v12, 4, v11
    v_lshl_add_u32 v16, v11, 4, v10
    v_lshl_add_u32 v17, v12, 4, v10
    v_add_u32 v18, 47104, v16
    v_add_u32 v19, 70656, v17
    v_add_u32 v17, 23552, v17
    s_getpc_b64 s[48:49]
L_pc:
    v_lshrrev_b32 v10, 4, v0
    v_and_or_b32 v10, v0, 3, v10
    v_lshl_add_u32 v10, s97, 4, v10
    v_lshlrev_b32 v10, 6, v10
    v_min_u32 v10, L_end-L_pc, v10
    s_mov_b64 exec, 15
    global_load_dword v207, v10, s[48:49]
    s_mov_b64 exec, -1
    s_load_dwordx2 s[48:49], s[30:31], 0
    s_mov_b32 s36, s18
    s_and_b32 s37, s19, 0xffff
    s_mul_i32 s38, s77, 6291456
    s_mov_b32 s39, 0x20000
    s_mov_b32 s40, s6
    s_and_b32 s41, s7, 0xffff
    s_mov_b32 s42, 2621440
    s_mov_b32 s43, 0x20000
    s_mul_i32 s99, s51, 10240
    v_lshl_add_u32 v240, v0, 2, s99
    v_add_u32 v241, 5120, v240
    v_subrev_u32 v242, 3840, v240
    v_lshlrev_b32 v243, 4, v0
    buffer_load_dword v127, v240, s[40:43], 0 offen offset:0
    buffer_load_dword v128, v240, s[40:43], 0 offen offset:1280
    buffer_load_dword v129, v240, s[40:43], 0 offen offset:2560
    buffer_load_dword v130, v240, s[40:43], 0 offen offset:3840
    buffer_load_dword v131, v241, s[40:43], 0 offen offset:0
    buffer_load_dword v132, v241, s[40:43], 0 offen offset:1280
    buffer_load_dword v133, v241, s[40:43], 0 offen offset:2560
    buffer_load_dword v134, v241, s[40:43], 0 offen offset:3840
    buffer_load_dword v124, v242, s[40:43], 0 offen offset:0
    buffer_load_dword v125, v242, s[40:43], 0 offen offset:1280
    buffer_load_dword v126, v242, s[40:43], 0 offen offset:2560
    global_load_dwordx4 v[120:123], v243, s[10:11]
    s_add_u32 s76, s58, 0
    s_and_b32 s76, s76, 7
    s_mul_i32 s76, s76, 98304
    s_add_u32 m0, s59, 0
    s_nop 0
    buffer_load_dwordx4 v16, s[36:39], s76 offen offset:0 lds
    buffer_load_dwordx4 v17, s[36:39], s76 offen offset:1024 lds
    buffer_load_dwordx4 v18, s[36:39], s76 offen offset:2048 lds
    buffer_load_dwordx4 v19, s[36:39], s76 offen offset:3072 lds
    s_mul_i32 s99, s51, 10240
    v_mul_u32_u24 v10, 2560, v2
    s_lshl_b32 s98, s50, 6
    v_lshl_add_u32 v11, v3, 2, s98
    s_add_u32 s99, s99, 4864
    v_sub_u32 v10, v11, v10
    v_add_u32 v156, s99, v10
    v_lshlrev_b32 v11, 2, v11
    v_add_u32 v160, 4096, v11
    v_add_u32 v157, 1280, v156
    v_add_u32 v158, 2560, v156
    v_add_u32 v159, 3840, v156
    v_lshrrev_b32 v10, 2, v3
    v_lshl_add_u32 v10, v2, 3, v10
    v_lshlrev_b32 v10, 7, v10
    v_and_b32 v11, 3, v3
    v_lshl_add_u32 v10, v11, 3, v10
    v_bfe_u32 v11, v1, 3, 2
    v_lshl_add_u32 v10, v11, 5, v10
    v_add_u32 v20, s59, v10
    v_xor_b32 v21, 32, v20
    v_xor_b32 v22, 64, v20
    v_xor_b32 v23, 0x60, v20
    s_mov_b32 s94, 2146435072
    s_mov_b32 s32, s30
    s_and_b32 s33, s31, 0xffff
    s_mov_b32 s34, 14352384
    s_mov_b32 s35, 0x20000
    v_lshlrev_b32 v236, 4, v8
    v_lshlrev_b32 v237, 3, v8
    v_mul_u32_u24 v10, 1344, v9
    s_mov_b32 s98, 147840
    v_add3_u32 v44, v10, v236, s98
    v_add3_u32 v45, v10, v237, s98
    v_lshrrev_b32 v10, 2, v3
    v_mul_u32_u24 v10, 1312, v10
    v_lshl_add_u32 v10, v3, 3, v10
    v_lshrrev_b32 v11, 4, v0
    v_lshlrev_b32 v11, 5, v11
    v_add3_u32 v46, v10, v11, s98
    s_mul_i32 s98, s51, 10240
    s_add_u32 s98, s98, 262144
    v_lshl_add_u32 v47, v0, 4, s98
    v_add_u32 v48, 4096, v47
    s_cmp_lt_u32 s50, 2
    s_cselect_b32 s98, 8192, s94
    v_add_u32 v49, s98, v47
    v_add_u32 v57, 2621440, v47
    v_add_u32 v59, 5120, v57
    s_lshl_b32 s98, s51, 5
    s_add_u32 s98, s98, 98304
    v_lshl_add_u32 v238, v9, 2, s98
    s_mov_b32 s7, 40960
    s_and_b32 s54, s51, 7
    s_lshr_b32 s55, s51, 3
    s_lshl_b32 s95, s54, 2
    s_lshr_b32 s95, 0xa9764310, s95
    s_and_b32 s95, s95, 15
    s_mov_b32 s44, s12
    s_and_b32 s45, s13, 0xffff
    s_mov_b32 s46, 2621440
    s_mov_b32 s47, 0x20000
    s_and_b32 s99, s51, 1
    s_sub_u32 s57, 3, s99
    s_mul_i32 s98, s51, 5
    s_add_u32 s98, s98, s99
    s_lshr_b32 s56, s98, 1
    s_cmp_ge_u32 s51, 128
    s_cselect_b32 s99, 639, 0
    s_sub_u32 s96, s98, s99
    s_lshl1_add_u32 s12, s57, s96
    s_sub_u32 s12, s12, 2
    s_and_b32 s99, s50, 2
    s_add_u32 s13, s96, s99
    s_lshl_b32 s98, s50, 10
    v_lshl_add_u32 v10, v1, 3, s98
    v_lshl_add_u32 v161, s96, 12, v10
    v_add_u32 v162, 8192, v161
    v_lshl_add_u32 v163, s12, 12, v10
    s_lshl1_add_u32 s98, s50, s96
    s_min_u32 s98, s98, s12
    s_lshl_b32 s98, s98, 12
    v_subrev_u32 v10, 8, v1
    v_lshl_add_u32 v11, v10, 2, s98
    v_and_or_b32 v164, v10, 2.0, v11
    v_subrev_u32 v10, 7, v1
    v_lshl_add_u32 v11, v10, 2, s98
    v_and_or_b32 v165, v10, 2.0, v11
    v_subrev_u32 v10, 6, v1
    v_lshl_add_u32 v11, v10, 2, s98
    v_and_or_b32 v166, v10, 2.0, v11
    v_lshrrev_b32 v10, 2, v1
    v_lshl_add_u32 v10, v10, 1, s96
    v_min_u32 v10, s12, v10
    v_lshlrev_b32 v204, 1, v10
    v_lshlrev_b32 v205, 12, v10
    s_min_u32 s98, s53, 23
    s_lshl_b32 s98, s98, 7
    v_lshl_add_u32 v206, v8, 2, s98
    s_waitcnt vmcnt(17)
    global_load_dwordx4 v[96:99], v236, s[26:27]
    s_mov_b32 s98, 0x3f803f80
    v_dot2_f32_bf16 v10, v64, s98, 0
    v_dot2_f32_bf16 v10, v65, s98, v10
    v_dot2_f32_bf16 v10, v66, s98, v10
    v_dot2_f32_bf16 v10, v67, s98, v10
    v_dot2_f32_bf16 v10, v68, s98, v10
    v_dot2_f32_bf16 v10, v69, s98, v10
    v_dot2_f32_bf16 v10, v70, s98, v10
    global_load_dwordx4 v[100:103], v236, s[26:27] offset:512
    v_dot2_f32_bf16 v10, v71, s98, v10
    v_dot2_f32_bf16 v10, v72, s98, v10
    v_dot2_f32_bf16 v10, v73, s98, v10
    v_lshlrev_b32 v76, 16, v64
    v_and_b32 v77, 0xffff0000, v64
    v_lshlrev_b32 v78, 16, v65
    v_add_f32 v10, v10, v10 row_ror:8
    v_and_b32 v79, 0xffff0000, v65
    global_load_dwordx2 v[104:105], v237, s[26:27] offset:1024
    v_lshlrev_b32 v80, 16, v66
    v_add_f32 v10, v10, v10 row_ror:4
    v_and_b32 v81, 0xffff0000, v66
    v_lshlrev_b32 v82, 16, v67
    v_add_f32 v10, v10, v10 row_ror:2
    v_and_b32 v83, 0xffff0000, v67
    v_lshlrev_b32 v84, 16, v68
    v_add_f32 v10, v10, v10 row_ror:1
    global_load_dword v135, v240, s[8:9] offset:0
    v_mov_b32 v11, v10
    v_and_b32 v85, 0xffff0000, v68
    v_lshlrev_b32 v86, 16, v69
    v_permlane16_swap_b32 v10, v11
    v_add_f32 v10, v10, v11
    v_and_b32 v87, 0xffff0000, v69
    v_lshlrev_b32 v88, 16, v70
    v_and_b32 v89, 0xffff0000, v70
    global_load_dword v136, v240, s[8:9] offset:1280
    v_lshlrev_b32 v90, 16, v71
    v_and_b32 v91, 0xffff0000, v71
    v_lshlrev_b32 v92, 16, v72
    v_and_b32 v93, 0xffff0000, v72
    v_lshlrev_b32 v94, 16, v73
    v_and_b32 v95, 0xffff0000, v73
    v_mul_f32 v10, 0xbacccccd, v10
    v_pk_add_f32 v[76:77], v[76:77], v[10:11] op_sel_hi:[1,0]
    global_load_dword v137, v240, s[8:9] offset:2560
    v_pk_add_f32 v[78:79], v[78:79], v[10:11] op_sel_hi:[1,0]
    v_pk_add_f32 v[80:81], v[80:81], v[10:11] op_sel_hi:[1,0]
    v_pk_add_f32 v[82:83], v[82:83], v[10:11] op_sel_hi:[1,0]
    v_pk_add_f32 v[84:85], v[84:85], v[10:11] op_sel_hi:[1,0]
    v_pk_add_f32 v[86:87], v[86:87], v[10:11] op_sel_hi:[1,0]
    v_pk_add_f32 v[88:89], v[88:89], v[10:11] op_sel_hi:[1,0]
    v_pk_add_f32 v[90:91], v[90:91], v[10:11] op_sel_hi:[1,0]
    v_pk_add_f32 v[92:93], v[92:93], v[10:11] op_sel_hi:[1,0]
    global_load_dword v138, v240, s[8:9] offset:3840
    v_pk_add_f32 v[94:95], v[94:95], v[10:11] op_sel_hi:[1,0]
    v_pk_mul_f32 v[10:11], v[76:77], v[76:77]
    v_pk_mul_f32 v[12:13], v[78:79], v[78:79]
    v_pk_fma_f32 v[10:11], v[80:81], v[80:81], v[10:11]
    v_pk_fma_f32 v[12:13], v[82:83], v[82:83], v[12:13]
    v_pk_fma_f32 v[10:11], v[84:85], v[84:85], v[10:11]
    v_pk_fma_f32 v[12:13], v[86:87], v[86:87], v[12:13]
    v_pk_fma_f32 v[10:11], v[88:89], v[88:89], v[10:11]
    global_load_dword v139, v241, s[8:9] offset:0
    v_pk_fma_f32 v[12:13], v[90:91], v[90:91], v[12:13]
    v_pk_fma_f32 v[10:11], v[92:93], v[92:93], v[10:11]
    v_pk_fma_f32 v[12:13], v[94:95], v[94:95], v[12:13]
    v_pk_add_f32 v[10:11], v[10:11], v[12:13]
    v_add_f32 v10, v10, v11
    s_nop 1
    v_add_f32 v10, v10, v10 row_ror:8
    s_nop 1
    v_add_f32 v10, v10, v10 row_ror:4
    s_nop 1
    v_add_f32 v10, v10, v10 row_ror:2
    global_load_dword v140, v241, s[8:9] offset:1280
    s_nop 0
    v_add_f32 v10, v10, v10 row_ror:1
    v_mov_b32 v11, v10
    s_nop 1
    v_permlane16_swap_b32 v10, v11
    v_add_f32 v10, v10, v11
    v_mov_b32 v11, 0x3727c5ac
    v_fmac_f32 v11, 0x3acccccd, v10
    v_rsq_f32 v10, v11
    s_nop 0
    v_pk_mul_f32 v[76:77], v[76:77], v[10:11] op_sel_hi:[1,0]
    global_load_dword v141, v241, s[8:9] offset:2560
    v_pk_mul_f32 v[78:79], v[78:79], v[10:11] op_sel_hi:[1,0]
    v_pk_mul_f32 v[80:81], v[80:81], v[10:11] op_sel_hi:[1,0]
    v_pk_mul_f32 v[82:83], v[82:83], v[10:11] op_sel_hi:[1,0]
    v_pk_mul_f32 v[84:85], v[84:85], v[10:11] op_sel_hi:[1,0]
    v_pk_mul_f32 v[86:87], v[86:87], v[10:11] op_sel_hi:[1,0]
    v_pk_mul_f32 v[88:89], v[88:89], v[10:11] op_sel_hi:[1,0]
    v_pk_mul_f32 v[90:91], v[90:91], v[10:11] op_sel_hi:[1,0]
    v_pk_mul_f32 v[92:93], v[92:93], v[10:11] op_sel_hi:[1,0]
    global_load_dword v142, v241, s[8:9] offset:3840
    v_pk_mul_f32 v[94:95], v[94:95], v[10:11] op_sel_hi:[1,0]
    v_cvt_pk_bf16_f32 v108, v76, v77
    v_cvt_pk_bf16_f32 v109, v78, v79
    v_cvt_pk_bf16_f32 v110, v80, v81
    v_cvt_pk_bf16_f32 v111, v82, v83
    v_cvt_pk_bf16_f32 v112, v84, v85
    v_cvt_pk_bf16_f32 v113, v86, v87
    v_cvt_pk_bf16_f32 v114, v88, v89
    buffer_load_dword v148, v156, s[40:43], 0 offen offset:0
    v_cvt_pk_bf16_f32 v115, v90, v91
    v_cvt_pk_bf16_f32 v116, v92, v93
    v_cvt_pk_bf16_f32 v117, v94, v95
    ds_write_b128 v44, v[108:111]
    ds_write_b128 v44, v[112:115] offset:512
    ds_write_b64 v45, v[116:117] offset:1024
    s_waitcnt lgkmcnt(0)
    s_barrier
    buffer_load_dword v149, v157, s[40:43], 0 offen offset:0
    ds_read_b64_tr_b16 v[108:109], v46 offset:0
    ds_read_b64_tr_b16 v[110:111], v46 offset:5376
    ds_read_b64_tr_b16 v[112:113], v46 offset:512
    ds_read_b64_tr_b16 v[114:115], v46 offset:5888
    ds_read_b64_tr_b16 v[116:117], v46 offset:1024
    ds_read_b64_tr_b16 v[118:119], v46 offset:6400
    s_add_u32 s48, s48, 0x9e3779b1
    s_add_u32 s49, s49, 0x85ebca77
    buffer_load_dword v150, v158, s[40:43], 0 offen offset:0
    v_mov_b32 v4, s48
    v_mov_b32 v5, s49
    s_waitcnt lgkmcnt(4)
    buffer_store_dwordx4 v[108:111], v47, s[32:35], 0 offen sc1
    s_waitcnt lgkmcnt(2)
    buffer_store_dwordx4 v[112:115], v48, s[32:35], 0 offen sc1
    s_waitcnt lgkmcnt(0)
    buffer_store_dwordx4 v[116:119], v49, s[32:35], 0 offen sc1
    buffer_load_dword v151, v159, s[40:43], 0 offen offset:0
    s_lshl_b32 s99, s52, 10
    s_add_u32 s98, s58, 0
    s_and_b32 s98, s98, 7
    s_mul_i32 s98, s98, s7
    s_add_u32 s68, s98, s99
    s_xor_b32 s60, s68, 1024
    s_add_u32 s98, s58, 1
    s_and_b32 s98, s98, 7
    buffer_load_dword v152, v159, s[40:43], 0 offen offset:1280
    s_mul_i32 s98, s98, s7
    s_add_u32 s69, s98, s99
    s_xor_b32 s61, s69, 1024
    s_add_u32 s98, s58, 2
    s_and_b32 s98, s98, 7
    s_mul_i32 s98, s98, s7
    s_add_u32 s70, s98, s99
    s_xor_b32 s62, s70, 1024
    global_load_dword v153, v159, s[8:9] offset:0
    s_add_u32 s98, s58, 3
    s_and_b32 s98, s98, 7
    s_mul_i32 s98, s98, s7
    s_add_u32 s71, s98, s99
    s_xor_b32 s63, s71, 1024
    s_add_u32 s98, s58, 4
    s_and_b32 s98, s98, 7
    s_mul_i32 s98, s98, s7
    global_load_dword v154, v159, s[8:9] offset:1280
    s_add_u32 s72, s98, s99
    s_xor_b32 s64, s72, 1024
    s_add_u32 s98, s58, 5
    s_and_b32 s98, s98, 7
    s_mul_i32 s98, s98, s7
    s_add_u32 s73, s98, s99
    s_xor_b32 s65, s73, 1024
    s_add_u32 s98, s58, 6
    global_load_dwordx4 v[144:147], v160, s[10:11]
    s_and_b32 s98, s98, 7
    s_mul_i32 s98, s98, s7
    s_add_u32 s74, s98, s99
    s_xor_b32 s66, s74, 1024
    s_add_u32 s98, s58, 7
    s_and_b32 s98, s98, 7
    s_mul_i32 s98, s98, s7
    s_add_u32 s75, s98, s99
    buffer_load_dword v192, v164, s[44:47], 0 offen
    s_xor_b32 s67, s75, 1024
    s_lshl_b32 s98, s52, 2
    s_add_u32 s98, s98, s50
    s_mul_i32 s99, s53, 80
    s_add_u32 s99, s99, s98
    s_lshl_b32 s99, s99, 10
    s_add_u32 s99, s99, 5505024
    s_cmp_eq_u32 s77, 1
    s_cselect_b32 s99, s99, s94
    v_lshl_add_u32 v245, v1, 4, s99
    buffer_load_dword v193, v165, s[44:47], 0 offen
    s_mul_i32 s98, s98, 24
    s_add_u32 s98, s98, s53
    s_lshl_b32 s99, s98, 12
    s_add_u32 s99, s99, 10223616
    s_cmp_eq_u32 s77, 1
    s_cselect_b32 s99, s99, s94
    v_lshl_add_u32 v244, v1, 4, s99
    s_bitcmp1_b32 s52, 0
    s_cselect_b32 s99, -1, 1
    s_mul_i32 s99, s99, 393216
    v_add_u32 v243, s99, v244
    s_mul_i32 s98, s52, 24
    buffer_load_dword v194, v166, s[44:47], 0 offen
    s_add_u32 s98, s98, s53
    s_lshl_b32 s98, s98, 4
    s_add_u32 s98, s98, 10092544
    s_cmp_eq_u32 s77, 1
    s_cselect_b32 s6, s98, 2048
    v_lshlrev_b32 v46, 4, v0
    v_add_u32 v46, 4096, v46
    s_and_b32 s98, s52, 2
    s_lshl_b32 s98, s98, 3
    s_add_u32 s98, s98, s3
    buffer_load_dwordx4 v[168:171], v161, s[44:47], 0 offen offset:0
    s_lshl_b32 s98, s98, 9
    s_add_u32 s98, s98, 14155776
    v_lshrrev_b32 v10, 5, v1
    v_and_b32 v11, 31, v1
    v_lshl_add_u32 v10, v10, 8, v11
    v_lshl_add_u32 v38, v10, 4, s98
    v_mul_u32_u24 v10, 10240, v2
    v_lshl_add_u32 v10, v3, 4, v10
    buffer_load_dwordx4 v[172:175], v161, s[44:47], 0 offen offset:512
    s_mul_i32 s98, s3, 327680
    s_add_u32 s98, s98, 262144
    s_cmp_eq_u32 s77, 1
    s_cselect_b32 s98, s98, s94
    s_add_u32 s99, s50, 1
    s_and_b32 s99, s99, 3
    s_lshl_b32 s99, s99, 8
    s_add_u32 s99, s99, s98
    v_add_u32 v24, s99, v10
    s_add_u32 s99, s50, 2
    buffer_load_dwordx4 v[176:179], v162, s[44:47], 0 offen offset:0
    s_and_b32 s99, s99, 3
    s_lshl_b32 s99, s99, 8
    s_add_u32 s99, s99, s98
    v_add_u32 v25, s99, v10
    s_add_u32 s99, s50, 3
    s_and_b32 s99, s99, 3
    s_lshl_b32 s99, s99, 8
    s_add_u32 s99, s99, s98
    buffer_load_dwordx4 v[180:183], v162, s[44:47], 0 offen offset:512
    v_add_u32 v26, s99, v10
    s_add_u32 s99, s50, 4
    s_and_b32 s99, s99, 3
    s_lshl_b32 s99, s99, 8
    s_add_u32 s99, s99, s98
    v_add_u32 v27, s99, v10
    v_lshl_add_u32 v43, v1, 4, s59
    s_add_u32 s99, s50, 3
    buffer_load_dwordx4 v[184:187], v163, s[44:47], 0 offen offset:0
    s_and_b32 s99, s99, 3
    s_mul_i32 s99, s99, 24576
    v_lshl_add_u32 v40, v1, 4, s99
    s_add_u32 s99, s50, 2
    s_and_b32 s99, s99, 3
    s_mul_i32 s99, s99, 24576
    v_lshl_add_u32 v41, v1, 4, s99
    s_add_u32 s99, s50, 1
    buffer_load_dwordx4 v[188:191], v163, s[44:47], 0 offen offset:512
    s_and_b32 s99, s99, 3
    s_mul_i32 s99, s99, 24576
    v_lshl_add_u32 v42, v1, 4, s99
    v_lshlrev_b32 v47, 3, v1
    s_lshl_b32 s98, s50, 8
    s_add_u32 s98, s98, s51
    s_lshl_b32 s98, s98, 4
    s_add_u32 s98, s98, 14155776
    s_add_u32 s76, s58, 1
    s_and_b32 s76, s76, 7
    s_mul_i32 s76, s76, 98304
    s_add_u32 m0, s59, 4096
    s_nop 0
    buffer_load_dwordx4 v16, s[36:39], s76 offen offset:0 lds
    s_waitcnt vmcnt(15)
    s_mov_b64 exec, 3
    buffer_store_dwordx2 v[4:5], v47, s[32:35], s98 offen sc1
    s_mov_b64 exec, -1
    v_mov_b32 v10, 0
    v_dot2_f32_bf16 v10, v64, v96, v10
    v_dot2_f32_bf16 v10, v65, v97, v10
    v_dot2_f32_bf16 v10, v66, v98, v10
    v_dot2_f32_bf16 v10, v67, v99, v10
    v_dot2_f32_bf16 v10, v68, v100, v10
    v_dot2_f32_bf16 v10, v69, v101, v10
    v_dot2_f32_bf16 v10, v70, v102, v10
    v_dot2_f32_bf16 v10, v71, v103, v10
    v_dot2_f32_bf16 v10, v72, v104, v10
    v_dot2_f32_bf16 v10, v73, v105, v10
    buffer_load_dwordx4 v17, s[36:39], s76 offen offset:1024 lds
    s_nop 1
    v_add_f32 v10, v10, v10 row_ror:8
    s_nop 1
    v_add_f32 v10, v10, v10 row_ror:4
    s_nop 1
    v_add_f32 v10, v10, v10 row_ror:2
    s_nop 1
    v_add_f32 v10, v10, v10 row_ror:1
    v_mov_b32 v11, v10
    s_nop 1
    v_permlane16_swap_b32 v10, v11
    v_add_f32 v10, v10, v11
    v_mul_f32 v10, 0xbfb8aa3b, v10
    v_exp_f32 v10, v10
    s_nop 0
    v_add_f32 v10, 1.0, v10
    v_rcp_f32 v61, v10
    s_waitcnt vmcnt(12)
    v_lshlrev_b32 v64, 16, v144
    buffer_load_dwordx4 v18, s[36:39], s76 offen offset:2048 lds
    v_and_b32 v66, 0xffff0000, v144
    v_lshlrev_b32 v68, 16, v145
    v_and_b32 v70, 0xffff0000, v145
    v_lshlrev_b32 v65, 16, v146
    v_and_b32 v67, 0xffff0000, v146
    v_lshlrev_b32 v69, 16, v147
    v_and_b32 v71, 0xffff0000, v147
    v_lshlrev_b32 v72, 16, v148
    v_and_b32 v73, 0xffff0000, v148
    v_lshlrev_b32 v74, 16, v149
    v_and_b32 v75, 0xffff0000, v149
    v_lshlrev_b32 v76, 16, v150
    v_and_b32 v77, 0xffff0000, v150
    buffer_load_dwordx4 v19, s[36:39], s76 offen offset:3072 lds
    v_lshlrev_b32 v78, 16, v151
    v_and_b32 v79, 0xffff0000, v151
    v_lshlrev_b32 v80, 16, v152
    v_and_b32 v81, 0xffff0000, v152
    v_lshlrev_b32 v82, 16, v153
    v_and_b32 v83, 0xffff0000, v153
    v_lshlrev_b32 v84, 16, v154
    v_and_b32 v85, 0xffff0000, v154
    v_pk_mul_f32 v[94:95], v[70:71], v[72:73]
    v_pk_fma_f32 v[94:95], v[68:69], v[74:75], v[94:95]
    v_pk_fma_f32 v[94:95], v[66:67], v[76:77], v[94:95]
    v_pk_fma_f32 v[94:95], v[64:65], v[78:79], v[94:95]
    v_pk_mul_f32 v[94:95], v[94:95], v[82:83]
    global_load_ushort v246, v204, s[14:15]
    v_pk_mul_f32 v[96:97], v[70:71], v[74:75]
    v_pk_fma_f32 v[96:97], v[68:69], v[76:77], v[96:97]
    v_pk_fma_f32 v[96:97], v[66:67], v[78:79], v[96:97]
    v_pk_fma_f32 v[96:97], v[64:65], v[80:81], v[96:97]
    v_pk_mul_f32 v[96:97], v[96:97], v[84:85]
    s_mul_i32 s98, s51, 10240
    s_add_u32 s98, s98, 2887680
    s_lshl_b32 s99, s50, 8
    s_add_u32 s98, s98, s99
    v_lshl_add_u32 v10, v3, 4, s98
    v_cvt_pk_bf16_f32 v232, v96, v94
    v_cvt_pk_bf16_f32 v234, v97, v95
    v_lshrrev_b32 v11, 1, v2
    buffer_load_ushort v247, v205, s[44:47], 0 offen
    v_mul_u32_u24 v11, 5120, v11
    v_permlane32_swap_b32 v232, v234
    v_add_u32 v10, v10, v11
    v_lshlrev_b32 v11, 30, v2
    v_mov_b32 v233, v232
    v_mov_b32 v235, v234
    v_and_or_b32 v63, v11, 2.0, v10
    v_permlane16_swap_b32 v232, v233
    v_permlane16_swap_b32 v234, v235
    v_lshlrev_b32 v64, 16, v120
    v_and_b32 v66, 0xffff0000, v120
    v_lshlrev_b32 v68, 16, v121
    v_and_b32 v70, 0xffff0000, v121
    s_mov_b32 m0, 163328
    s_nop 0
    global_load_lds_dword v206, s[20:21]
    v_lshlrev_b32 v65, 16, v122
    v_and_b32 v67, 0xffff0000, v122
    v_lshlrev_b32 v69, 16, v123
    v_and_b32 v71, 0xffff0000, v123
    v_lshlrev_b32 v72, 16, v124
    v_and_b32 v73, 0xffff0000, v124
    v_lshlrev_b32 v74, 16, v125
    v_and_b32 v75, 0xffff0000, v125
    v_lshlrev_b32 v76, 16, v126
    v_and_b32 v77, 0xffff0000, v126
    v_lshlrev_b32 v78, 16, v127
    v_and_b32 v79, 0xffff0000, v127
    v_lshlrev_b32 v80, 16, v128
    ds_read_b64_tr_b16 a[0:1], v20 offset:0
    ds_read_b64_tr_b16 a[2:3], v20 offset:512
    ds_read_b64_tr_b16 a[4:5], v21 offset:0
    ds_read_b64_tr_b16 a[6:7], v21 offset:512
    v_and_b32 v81, 0xffff0000, v128
    v_lshlrev_b32 v82, 16, v129
    v_and_b32 v83, 0xffff0000, v129
    v_lshlrev_b32 v84, 16, v130
    v_and_b32 v85, 0xffff0000, v130
    v_lshlrev_b32 v86, 16, v131
    v_and_b32 v87, 0xffff0000, v131
    v_lshlrev_b32 v88, 16, v132
    v_and_b32 v89, 0xffff0000, v132
    v_lshlrev_b32 v90, 16, v133
    v_and_b32 v91, 0xffff0000, v133
    v_lshlrev_b32 v92, 16, v134
    v_and_b32 v93, 0xffff0000, v134
    ds_read_b64_tr_b16 a[8:9], v22 offset:0
    ds_read_b64_tr_b16 a[10:11], v22 offset:512
    ds_read_b64_tr_b16 a[12:13], v23 offset:0
    ds_read_b64_tr_b16 a[14:15], v23 offset:512
    v_pk_mul_f32 v[94:95], v[70:71], v[72:73]
    v_lshlrev_b32 v110, 16, v135
    v_pk_fma_f32 v[94:95], v[68:69], v[74:75], v[94:95]
    v_pk_fma_f32 v[94:95], v[66:67], v[76:77], v[94:95]
    v_pk_fma_f32 v[94:95], v[64:65], v[78:79], v[94:95]
    v_and_b32 v111, 0xffff0000, v135
    v_pk_mul_f32 v[94:95], v[94:95], v[110:111]
    v_pk_mul_f32 v[96:97], v[70:71], v[74:75]
    v_lshlrev_b32 v110, 16, v136
    v_pk_fma_f32 v[96:97], v[68:69], v[76:77], v[96:97]
    v_pk_fma_f32 v[96:97], v[66:67], v[78:79], v[96:97]
    v_pk_fma_f32 v[96:97], v[64:65], v[80:81], v[96:97]
    v_and_b32 v111, 0xffff0000, v136
    s_add_u32 s76, s58, 2
    s_and_b32 s76, s76, 7
    s_mul_i32 s76, s76, 98304
    s_add_u32 m0, s59, 8192
    s_nop 0
    buffer_load_dwordx4 v16, s[36:39], s76 offen offset:0 lds
    v_pk_mul_f32 v[96:97], v[96:97], v[110:111]
    v_pk_mul_f32 v[98:99], v[70:71], v[76:77]
    v_lshlrev_b32 v110, 16, v137
    v_pk_fma_f32 v[98:99], v[68:69], v[78:79], v[98:99]
    v_pk_fma_f32 v[98:99], v[66:67], v[80:81], v[98:99]
    v_pk_fma_f32 v[98:99], v[64:65], v[82:83], v[98:99]
    v_and_b32 v111, 0xffff0000, v137
    v_pk_mul_f32 v[98:99], v[98:99], v[110:111]
    v_pk_mul_f32 v[100:101], v[70:71], v[78:79]
    v_lshlrev_b32 v110, 16, v138
    v_pk_fma_f32 v[100:101], v[68:69], v[80:81], v[100:101]
    v_pk_fma_f32 v[100:101], v[66:67], v[82:83], v[100:101]
    v_pk_fma_f32 v[100:101], v[64:65], v[84:85], v[100:101]
    buffer_load_dwordx4 v17, s[36:39], s76 offen offset:1024 lds
    v_and_b32 v111, 0xffff0000, v138
    v_pk_mul_f32 v[100:101], v[100:101], v[110:111]
    v_pk_mul_f32 v[102:103], v[70:71], v[80:81]
    v_lshlrev_b32 v110, 16, v139
    v_pk_fma_f32 v[102:103], v[68:69], v[82:83], v[102:103]
    v_pk_fma_f32 v[102:103], v[66:67], v[84:85], v[102:103]
    v_pk_fma_f32 v[102:103], v[64:65], v[86:87], v[102:103]
    v_and_b32 v111, 0xffff0000, v139
    v_pk_mul_f32 v[102:103], v[102:103], v[110:111]
    v_pk_mul_f32 v[104:105], v[70:71], v[82:83]
    v_lshlrev_b32 v110, 16, v140
    v_pk_fma_f32 v[104:105], v[68:69], v[84:85], v[104:105]
    v_pk_fma_f32 v[104:105], v[66:67], v[86:87], v[104:105]
    buffer_load_dwordx4 v18, s[36:39], s76 offen offset:2048 lds
    v_pk_fma_f32 v[104:105], v[64:65], v[88:89], v[104:105]
    v_and_b32 v111, 0xffff0000, v140
    v_pk_mul_f32 v[104:105], v[104:105], v[110:111]
    v_pk_mul_f32 v[106:107], v[70:71], v[84:85]
    v_lshlrev_b32 v110, 16, v141
    v_pk_fma_f32 v[106:107], v[68:69], v[86:87], v[106:107]
    v_pk_fma_f32 v[106:107], v[66:67], v[88:89], v[106:107]
    v_pk_fma_f32 v[106:107], v[64:65], v[90:91], v[106:107]
    v_and_b32 v111, 0xffff0000, v141
    v_pk_mul_f32 v[106:107], v[106:107], v[110:111]
    v_pk_mul_f32 v[108:109], v[70:71], v[86:87]
    v_lshlrev_b32 v110, 16, v142
    v_pk_fma_f32 v[108:109], v[68:69], v[88:89], v[108:109]
    buffer_load_dwordx4 v19, s[36:39], s76 offen offset:3072 lds
    v_pk_fma_f32 v[108:109], v[66:67], v[90:91], v[108:109]
    v_pk_fma_f32 v[108:109], v[64:65], v[92:93], v[108:109]
    v_and_b32 v111, 0xffff0000, v142
    v_pk_mul_f32 v[108:109], v[108:109], v[110:111]
    v_cvt_pk_bf16_f32 v224, v108, v106
    v_cvt_pk_bf16_f32 v225, v104, v102
    v_cvt_pk_bf16_f32 v226, v100, v98
    v_cvt_pk_bf16_f32 v227, v96, v94
    v_cvt_pk_bf16_f32 v228, v109, v107
    v_cvt_pk_bf16_f32 v229, v105, v103
    v_cvt_pk_bf16_f32 v230, v101, v99
    v_cvt_pk_bf16_f32 v231, v97, v95
    v_lshrrev_b32 v10, 2, v1
    s_add_u32 s76, s58, 3
    s_and_b32 s76, s76, 7
    s_mul_i32 s76, s76, 98304
    s_add_u32 m0, s59, 12288
    s_nop 0
    buffer_load_dwordx4 v16, s[36:39], s76 offen offset:0 lds
    v_and_b32 v11, 3, v1
    v_min_u32 v11, 2, v11
    v_mul_u32_u24 v12, 10240, v10
    v_lshl_add_u32 v12, v11, 4, v12
    s_mul_i32 s98, s50, 655360
    s_lshl_b32 s99, s56, 4
    s_add_u32 s98, s98, s99
    s_add_u32 s98, s98, 2883584
    v_add_u32 v12, s98, v12
    v_cmp_gt_u32 vcc, s57, v11
    v_mov_b32 v44, s94
    buffer_load_dwordx4 v17, s[36:39], s76 offen offset:1024 lds
    v_mul_u32_u24 v11, 4608, v11
    v_cndmask_b32 v44, v44, v12, vcc
    v_lshl_add_u32 v11, v10, 4, v11
    s_lshl_b32 s98, s50, 10
    s_add_u32 s98, s98, 148352
    v_add_u32 v45, s98, v11
    v_lshlrev_b32 v10, 7, v10
    v_and_b32 v11, 3, v3
    v_lshl_add_u32 v10, v11, 3, v10
    v_add_u32 v10, s59, v10
    v_bfe_u32 v11, v1, 3, 2
    buffer_load_dwordx4 v18, s[36:39], s76 offen offset:2048 lds
    s_add_u32 s98, s50, 0
    s_and_b32 s98, s98, 3
    v_xor_b32 v12, s98, v11
    v_lshl_add_u32 v248, v12, 5, v10
    s_add_u32 s98, s50, 1
    s_and_b32 s98, s98, 3
    v_xor_b32 v12, s98, v11
    v_lshl_add_u32 v249, v12, 5, v10
    s_add_u32 s98, s50, 2
    s_and_b32 s98, s98, 3
    v_xor_b32 v12, s98, v11
    buffer_load_dwordx4 v19, s[36:39], s76 offen offset:3072 lds
    v_lshl_add_u32 v250, v12, 5, v10
    s_add_u32 s98, s50, 3
    s_and_b32 s98, s98, 3
    v_xor_b32 v12, s98, v11
    v_lshl_add_u32 v251, v12, 5, v10
    v_lshlrev_b32 v10, 3, v3
    v_lshlrev_b32 v11, 6, v2
    v_sub_u32 v10, v10, v11
    s_lshl_b32 s98, s50, 9
    s_add_u32 s98, s98, 131528
    v_add_u32 v52, s98, v10
    s_add_u32 s76, s58, 4
    s_and_b32 s76, s76, 7
    s_mul_i32 s76, s76, 98304
    s_add_u32 m0, s59, 16384
    s_nop 0
    buffer_load_dwordx4 v16, s[36:39], s76 offen offset:0 lds
    s_lshr_b32 s98, s50, 1
    s_mul_i32 s98, s98, 16512
    s_and_b32 s99, s50, 1
    s_lshl_b32 s99, s99, 10
    s_add_u32 s98, s98, s99
    s_add_u32 s98, s98, 98504
    v_add_u32 v54, s98, v10
    v_lshlrev_b32 v10, 5, v3
    v_lshl_add_u32 v12, v2, 4, v10
    s_lshl_b32 s98, s50, 7
    s_sub_u32 s98, 157472, s98
    buffer_load_dwordx4 v17, s[36:39], s76 offen offset:1024 lds
    v_add_u32 v53, s98, v12
    s_lshr_b32 s98, s50, 1
    s_mul_i32 s98, s98, 4608
    s_lshr_b32 s99, s99, 2
    s_sub_u32 s98, s98, s99
    s_add_u32 s98, s98, 148128
    v_add_u32 v55, s98, v12
    s_lshl_b32 s98, s50, 11
    s_add_u32 s98, s98, 16384
    v_lshl_add_u32 v6, v1, 4, s98
    s_mul_i32 s98, 1, 49152
    buffer_load_dwordx4 v18, s[36:39], s76 offen offset:2048 lds
    v_add_u32 v7, s98, v6
    v_and_b32 v11, 1, v2
    v_lshl_add_u32 v10, v11, 9, v10
    v_lshrrev_b32 v11, 1, v2
    v_lshl_add_u32 v10, v11, 4, v10
    s_lshl_b32 s98, s12, 2
    s_add_u32 s98, s98, s50
    s_lshl_b32 s98, s98, 10
    s_add_u32 s98, s98, 7471104
    s_cmp_eq_u32 s57, 3
    s_cselect_b32 s98, s98, s94
    v_add_u32 v8, s98, v10
    s_and_b32 s98, s50, 1
    buffer_load_dwordx4 v19, s[36:39], s76 offen offset:3072 lds
    s_lshl1_add_u32 s98, s13, s98
    s_lshl_b32 s98, s98, 11
    s_add_u32 s98, s98, 7471104
    v_add_u32 v9, s98, v10
    s_lshl_b32 s98, s50, 12
    s_add_u32 s99, s98, 131328
    v_lshl_add_u32 v14, v1, 4, s99
    s_xor_b32 s98, s98, 4096
    s_add_u32 s99, s98, 131328
    v_lshl_add_u32 v15, v1, 4, s99
    s_mul_i32 s98, s50, 491520
    s_add_u32 s76, s58, 5
    s_and_b32 s76, s76, 7
    s_mul_i32 s76, s76, 98304
    s_add_u32 m0, s59, 20480
    s_nop 0
    buffer_load_dwordx4 v16, s[36:39], s76 offen offset:0 lds
    s_mul_i32 s99, s54, 5120
    s_add_u32 s98, s98, s99
    s_add_u32 s98, s98, 5505024
    v_lshl_add_u32 v48, v1, 4, s98
    v_add_u32 v49, 4096, v48
    v_min_u32 v10, 11, v1
    v_mul_u32_u24 v11, 43, v10
    v_lshrrev_b32 v11, 8, v11
    v_mul_u32_u24 v11, 18, v11
    v_add_u32 v10, v10, v11
    s_mul_i32 s98, s54, 5
    buffer_load_dwordx4 v17, s[36:39], s76 offen offset:1024 lds
    s_lshr_b32 s98, s98, 2
    s_mul_i32 s98, s98, 24
    s_mul_i32 s99, s50, 6
    s_add_u32 s98, s98, s99
    s_lshl_b32 s98, s98, 4
    s_add_u32 s98, s98, 10092544
    v_lshl_add_u32 v39, v10, 4, s98
    v_lshrrev_b32 v10, 3, v1
    v_lshlrev_b32 v10, 12, v10
    s_mul_i32 s98, s50, 1572864
    s_lshl_b32 s99, s55, 7
    buffer_load_dwordx4 v18, s[36:39], s76 offen offset:2048 lds
    s_add_u32 s98, s98, s99
    v_add_u32 v10, s98, v10
    v_and_b32 v11, 7, v1
    v_lshlrev_b32 v12, 1, v2
    v_xor_b32 v11, v11, v12
    v_lshl_add_u32 v252, v11, 4, v10
    v_add_u32 v253, 31744, v252
    v_add_u32 v254, 63488, v252
    v_add_u32 v255, 95232, v252
    buffer_load_dwordx2 v[36:37], v38, s[32:35], 0 offen sc1
    s_lshl_b32 s8, s95, 17
    buffer_load_dwordx4 v19, s[36:39], s76 offen offset:3072 lds
    s_mul_i32 s40, s95, s7
    s_add_u32 s95, s95, 1
    s_cmp_eq_u32 s95, 12
    s_cselect_b32 s95, 0, s95
    s_lshl_b32 s9, s95, 17
    s_mul_i32 s41, s95, s7
    s_add_u32 s95, s95, 1
    s_cmp_eq_u32 s95, 12
    s_cselect_b32 s95, 0, s95
    s_lshl_b32 s10, s95, 17
    s_mul_i32 s42, s95, s7
    s_add_u32 s95, s95, 1
    s_cmp_eq_u32 s95, 12
    s_cselect_b32 s95, 0, s95
    s_lshl_b32 s11, s95, 17
    s_mul_i32 s43, s95, s7
    s_add_u32 s95, s95, 1
    s_waitcnt lgkmcnt(0)
    s_add_u32 s76, s58, 6
    s_and_b32 s76, s76, 7
    s_mul_i32 s76, s76, 98304
    s_add_u32 m0, s59, 0
    s_nop 0
    buffer_load_dwordx4 v16, s[36:39], s76 offen offset:0 lds
    s_cmp_eq_u32 s95, 12
    s_cselect_b32 s95, 0, s95
    s_lshl_b32 s14, s95, 17
    s_mul_i32 s44, s95, s7
    s_add_u32 s95, s95, 1
    s_cmp_eq_u32 s95, 12
    s_cselect_b32 s95, 0, s95
    s_lshl_b32 s15, s95, 17
    s_mul_i32 s45, s95, s7
    s_add_u32 s95, s95, 1
    s_cmp_eq_u32 s95, 12
    s_cselect_b32 s95, 0, s95
    s_lshl_b32 s18, s95, 17
    s_mul_i32 s46, s95, s7
    s_add_u32 s95, s95, 1
    s_cmp_eq_u32 s95, 12
    s_cselect_b32 s95, 0, s95
    s_lshl_b32 s19, s95, 17
    s_mul_i32 s47, s95, s7
    buffer_load_dwordx4 v17, s[36:39], s76 offen offset:1024 lds
    s_add_u32 s95, s95, 1
    s_cmp_eq_u32 s95, 12
    s_cselect_b32 s95, 0, s95
    s_lshl_b32 s20, s95, 17
    s_mul_i32 s0, s95, s7
    s_add_u32 s95, s95, 1
    s_cmp_eq_u32 s95, 12
    s_cselect_b32 s95, 0, s95
    s_lshl_b32 s21, s95, 17
    s_mul_i32 s1, s95, s7
    s_add_u32 s95, s95, 1
    s_cmp_eq_u32 s95, 12
    s_cselect_b32 s95, 0, s95
    s_lshl_b32 s26, s95, 17
    s_mul_i32 s30, s95, s7
    s_add_u32 s95, s95, 1
    s_cmp_eq_u32 s95, 12
    s_cselect_b32 s95, 0, s95
    s_lshl_b32 s27, s95, 17
    buffer_load_dwordx4 v18, s[36:39], s76 offen offset:2048 lds
    s_mul_i32 s31, s95, s7
    buffer_load_dwordx4 v19, s[36:39], s76 offen offset:3072 lds
    s_waitcnt vmcnt(24)
    ds_read_b64_tr_b16 a[16:17], v20 offset:4096
    ds_read_b64_tr_b16 a[18:19], v20 offset:4608
    ds_read_b64_tr_b16 a[20:21], v21 offset:4096
    ds_read_b64_tr_b16 a[22:23], v21 offset:4608
    ds_read_b64_tr_b16 a[24:25], v22 offset:4096
    ds_read_b64_tr_b16 a[26:27], v22 offset:4608
    ds_read_b64_tr_b16 a[28:29], v23 offset:4096
    ds_read_b64_tr_b16 a[30:31], v23 offset:4608
    s_waitcnt vmcnt(17)
    ds_read_b64_tr_b16 a[32:33], v20 offset:8192
    ds_read_b64_tr_b16 a[34:35], v20 offset:8704
    ds_read_b64_tr_b16 a[36:37], v21 offset:8192
    ds_read_b64_tr_b16 a[38:39], v21 offset:8704
    ds_read_b64_tr_b16 a[40:41], v22 offset:8192
    ds_read_b64_tr_b16 a[42:43], v22 offset:8704
    ds_read_b64_tr_b16 a[44:45], v23 offset:8192
    ds_read_b64_tr_b16 a[46:47], v23 offset:8704
    s_waitcnt lgkmcnt(8)
    s_add_u32 s76, s58, 7
    s_and_b32 s76, s76, 7
    s_mul_i32 s76, s76, 98304
    s_add_u32 m0, s59, 4096
    s_nop 0
    buffer_load_dwordx4 v16, s[36:39], s76 offen offset:0 lds
    buffer_load_dwordx4 v17, s[36:39], s76 offen offset:1024 lds
    buffer_load_dwordx4 v18, s[36:39], s76 offen offset:2048 lds
    buffer_load_dwordx4 v19, s[36:39], s76 offen offset:3072 lds
    s_waitcnt vmcnt(17)
    ds_read_b64_tr_b16 a[48:49], v20 offset:12288
    ds_read_b64_tr_b16 a[50:51], v20 offset:12800
    ds_read_b64_tr_b16 a[52:53], v21 offset:12288
    ds_read_b64_tr_b16 a[54:55], v21 offset:12800
    ds_read_b64_tr_b16 a[56:57], v22 offset:12288
    ds_read_b64_tr_b16 a[58:59], v22 offset:12800
    ds_read_b64_tr_b16 a[60:61], v23 offset:12288
    ds_read_b64_tr_b16 a[62:63], v23 offset:12800
    s_min_u32 s98, s50, 2
    s_mul_i32 s98, s98, 16512
    s_add_u32 s98, s98, 98304
    v_lshl_add_u32 v240, v1, 4, s98
    s_lshl_b32 s98, s50, 12
    s_add_u32 s98, s98, 98432
    v_lshl_add_u32 v241, v1, 5, s98
    s_mov_b32 s36, s22
    s_and_b32 s37, s23, 0xffff
    s_mov_b32 s38, 6291456
    s_waitcnt vmcnt(9)
    v_cmp_ne_u64 vcc, s[48:49], v[36:37]
    s_cbranch_vccz L_pollh_ok
    s_mov_b32 s3, 0
L_pollh:
    s_mov_b64 exec, vcc
    buffer_load_dwordx2 v[36:37], v38, s[32:35], 0 offen sc1
    s_waitcnt vmcnt(0)
    v_cmp_ne_u64 vcc, s[48:49], v[36:37]
    s_add_u32 s3, s3, 1
    s_cbranch_vccz L_pollh_out
    s_cmp_lt_u32 s3, 200000
    s_cbranch_scc1 L_pollh
L_pollh_out:
    s_mov_b64 exec, -1
L_pollh_ok:
    buffer_load_dwordx4 v[96:99], v24, s[32:35], s60 offen sc1
    ds_read_b64_tr_b16 a[64:65], v20 offset:16384
    ds_read_b64_tr_b16 a[66:67], v20 offset:16896
    ds_read_b64_tr_b16 a[68:69], v21 offset:16384
    ds_read_b64_tr_b16 a[70:71], v21 offset:16896
    buffer_load_dwordx4 v[100:103], v24, s[32:35], s61 offen sc1
    ds_read_b64_tr_b16 a[72:73], v22 offset:16384
    ds_read_b64_tr_b16 a[74:75], v22 offset:16896
    ds_read_b64_tr_b16 a[76:77], v23 offset:16384
    ds_read_b64_tr_b16 a[78:79], v23 offset:16896
    buffer_load_dwordx4 v[104:107], v24, s[32:35], s62 offen sc1
    s_waitcnt vmcnt(11)
    ds_read_b64_tr_b16 a[80:81], v20 offset:20480
    ds_read_b64_tr_b16 a[82:83], v20 offset:20992
    ds_read_b64_tr_b16 a[84:85], v21 offset:20480
    ds_read_b64_tr_b16 a[86:87], v21 offset:20992
    buffer_load_dwordx4 v[108:111], v24, s[32:35], s63 offen sc1
    ds_read_b64_tr_b16 a[88:89], v22 offset:20480
    ds_read_b64_tr_b16 a[90:91], v22 offset:20992
    ds_read_b64_tr_b16 a[92:93], v23 offset:20480
    ds_read_b64_tr_b16 a[94:95], v23 offset:20992
    buffer_load_dwordx4 v[112:115], v24, s[32:35], s64 offen sc1
    s_waitcnt vmcnt(9)
    ds_read_b64_tr_b16 a[96:97], v20 offset:0
    ds_read_b64_tr_b16 a[98:99], v20 offset:512
    ds_read_b64_tr_b16 a[100:101], v21 offset:0
    ds_read_b64_tr_b16 a[102:103], v21 offset:512
    buffer_load_dwordx4 v[116:119], v24, s[32:35], s65 offen sc1
    ds_read_b64_tr_b16 a[104:105], v22 offset:0
    ds_read_b64_tr_b16 a[106:107], v22 offset:512
    ds_read_b64_tr_b16 a[108:109], v23 offset:0
    ds_read_b64_tr_b16 a[110:111], v23 offset:512
    buffer_load_dwordx4 v[120:123], v24, s[32:35], s66 offen sc1
    s_waitcnt vmcnt(7)
    ds_read_b64_tr_b16 a[112:113], v20 offset:4096
    ds_read_b64_tr_b16 a[114:115], v20 offset:4608
    ds_read_b64_tr_b16 a[116:117], v21 offset:4096
    ds_read_b64_tr_b16 a[118:119], v21 offset:4608
    buffer_load_dwordx4 v[124:127], v24, s[32:35], s67 offen sc1
    ds_read_b64_tr_b16 a[120:121], v22 offset:4096
    ds_read_b64_tr_b16 a[122:123], v22 offset:4608
    ds_read_b64_tr_b16 a[124:125], v23 offset:4096
    ds_read_b64_tr_b16 a[126:127], v23 offset:4608
    s_mov_b32 exec_lo, 1
    s_mov_b32 exec_hi, 1
    buffer_store_dword v61, v238, s[32:35], 0 offen sc1
    s_mov_b64 exec, -1
    buffer_store_dwordx4 v[232:235], v63, s[32:35], 0 offen sc1
    buffer_store_dwordx4 v[224:227], v57, s[32:35], 0 offen sc1
    buffer_store_dwordx4 v[228:231], v59, s[32:35], 0 offen sc1
    buffer_load_dwordx4 v[128:131], v25, s[32:35], s60 offen sc1
    buffer_load_dwordx4 v[132:135], v25, s[32:35], s61 offen sc1
    s_waitcnt vmcnt(13)
    v_mfma_f32_16x16x32_bf16 v[64:67], a[0:3], v[96:99], 0
    s_mul_i32 s58, s77, -1
    v_alignbit_b32 v195, v194, v193, 16
    v_alignbit_b32 v194, v193, v192, 16
    v_mfma_f32_16x16x32_bf16 v[68:71], a[4:7], v[96:99], 0
    ds_write_b128 v240, v[192:195] offset:0
    v_mov_b32 v196, v169
    v_mfma_f32_16x16x32_bf16 v[72:75], a[8:11], v[96:99], 0
    v_mov_b32 v197, v170
    v_alignbit_b32 v199, v171, v170, 16
    v_mfma_f32_16x16x32_bf16 v[76:79], a[12:15], v[96:99], 0
    s_waitcnt vmcnt(12)
    v_alignbit_b32 v198, v170, v169, 16
    v_mul_u32_u24 v204, 12, v1
    v_mfma_f32_16x16x32_bf16 v[64:67], a[16:19], v[100:103], v[64:67]
    buffer_load_dwordx4 v[96:99], v25, s[32:35], s62 offen sc1
    ds_write_b128 v241, v[196:199] offset:16
    v_mfma_f32_16x16x32_bf16 v[68:71], a[20:23], v[100:103], v[68:71]
    v_alignbit_b32 v171, v170, v169, 16
    v_alignbit_b32 v170, v169, v168, 16
    v_mfma_f32_16x16x32_bf16 v[72:75], a[24:27], v[100:103], v[72:75]
    v_sub_u32 v205, v243, v204
    v_sub_u32 v206, v244, v204
    v_mfma_f32_16x16x32_bf16 v[76:79], a[28:31], v[100:103], v[76:79]
    s_waitcnt vmcnt(12)
    s_waitcnt lgkmcnt(14)
    ds_write_b128 v241, v[168:171] offset:0
    v_mov_b32 v200, v173
    v_mfma_f32_16x16x32_bf16 v[64:67], a[32:35], v[104:107], v[64:67]
    buffer_load_dwordx4 v[100:103], v25, s[32:35], s63 offen sc1
    v_mov_b32 v201, v174
    v_mfma_f32_16x16x32_bf16 v[68:71], a[36:39], v[104:107], v[68:71]
    v_alignbit_b32 v203, v175, v174, 16
    v_alignbit_b32 v202, v174, v173, 16
    v_mfma_f32_16x16x32_bf16 v[72:75], a[40:43], v[104:107], v[72:75]
    ds_write_b128 v241, v[200:203] offset:2064
    v_alignbit_b32 v175, v174, v173, 16
    v_mfma_f32_16x16x32_bf16 v[76:79], a[44:47], v[104:107], v[76:79]
    s_waitcnt vmcnt(12)
    v_alignbit_b32 v174, v173, v172, 16
    v_lshlrev_b32 v10, 3, v2
    v_mfma_f32_16x16x32_bf16 v[64:67], a[48:51], v[108:111], v[64:67]
    buffer_load_dwordx4 v[104:107], v25, s[32:35], s64 offen sc1
    v_add_u32 v10, 163328, v10
    v_mfma_f32_16x16x32_bf16 v[68:71], a[52:55], v[108:111], v[68:71]
    ds_write_b128 v241, v[172:175] offset:2048
    v_mov_b32 v196, v177
    v_mfma_f32_16x16x32_bf16 v[72:75], a[56:59], v[108:111], v[72:75]
    v_mov_b32 v197, v178
    v_alignbit_b32 v199, v179, v178, 16
    v_mfma_f32_16x16x32_bf16 v[76:79], a[60:63], v[108:111], v[76:79]
    s_waitcnt vmcnt(12)
    v_alignbit_b32 v198, v178, v177, 16
    v_mfma_f32_16x16x32_bf16 v[64:67], a[64:67], v[112:115], v[64:67]
    buffer_load_dwordx4 v[108:111], v25, s[32:35], s65 offen sc1
    ds_write_b128 v241, v[196:199] offset:16528
    v_mfma_f32_16x16x32_bf16 v[68:71], a[68:71], v[112:115], v[68:71]
    v_alignbit_b32 v179, v178, v177, 16
    v_alignbit_b32 v178, v177, v176, 16
    v_mfma_f32_16x16x32_bf16 v[72:75], a[72:75], v[112:115], v[72:75]
    v_mfma_f32_16x16x32_bf16 v[76:79], a[76:79], v[112:115], v[76:79]
    s_waitcnt vmcnt(12)
    v_mfma_f32_16x16x32_bf16 v[64:67], a[80:83], v[116:119], v[64:67]
    buffer_load_dwordx4 v[112:115], v25, s[32:35], s66 offen sc1
    ds_write_b128 v241, v[176:179] offset:16512
    v_mfma_f32_16x16x32_bf16 v[68:71], a[84:87], v[116:119], v[68:71]
    v_mov_b32 v200, v181
    v_mov_b32 v201, v182
    v_mfma_f32_16x16x32_bf16 v[72:75], a[88:91], v[116:119], v[72:75]
    v_alignbit_b32 v203, v183, v182, 16
    v_alignbit_b32 v202, v182, v181, 16
    v_mfma_f32_16x16x32_bf16 v[76:79], a[92:95], v[116:119], v[76:79]
    s_waitcnt vmcnt(12)
    s_waitcnt lgkmcnt(14)
    ds_write_b128 v241, v[200:203] offset:18576
    v_alignbit_b32 v183, v182, v181, 16
    v_mfma_f32_16x16x32_bf16 v[64:67], a[96:99], v[120:123], v[64:67]
    buffer_load_dwordx4 v[116:119], v25, s[32:35], s67 offen sc1
    v_alignbit_b32 v182, v181, v180, 16
    v_mfma_f32_16x16x32_bf16 v[68:71], a[100:103], v[120:123], v[68:71]
    v_mfma_f32_16x16x32_bf16 v[72:75], a[104:107], v[120:123], v[72:75]
    ds_write_b128 v241, v[180:183] offset:18560
    v_mov_b32 v196, v185
    v_mfma_f32_16x16x32_bf16 v[76:79], a[108:111], v[120:123], v[76:79]
    s_waitcnt vmcnt(12)
    s_waitcnt lgkmcnt(9)
    v_mov_b32 v197, v186
    v_alignbit_b32 v199, v187, v186, 16
    v_mfma_f32_16x16x32_bf16 v[64:67], a[112:115], v[124:127], v[64:67]
    buffer_load_dwordx4 v[120:123], v26, s[32:35], s60 offen sc1
    v_alignbit_b32 v198, v186, v185, 16
    v_mfma_f32_16x16x32_bf16 v[68:71], a[116:119], v[124:127], v[68:71]
    ds_write_b128 v241, v[196:199] offset:33040
    v_alignbit_b32 v187, v186, v185, 16
    v_mfma_f32_16x16x32_bf16 v[72:75], a[120:123], v[124:127], v[72:75]
    v_alignbit_b32 v186, v185, v184, 16
    v_mfma_f32_16x16x32_bf16 v[76:79], a[124:127], v[124:127], v[76:79]
    s_waitcnt vmcnt(8)
    v_mfma_f32_16x16x32_bf16 v[80:83], a[0:3], v[128:131], 0
    buffer_load_dwordx4 v[124:127], v26, s[32:35], s61 offen sc1
    v_mfma_f32_16x16x32_bf16 v[84:87], a[4:7], v[128:131], 0
    ds_write_b128 v241, v[184:187] offset:33024
    v_mov_b32 v200, v189
    v_mfma_f32_16x16x32_bf16 v[88:91], a[8:11], v[128:131], 0
    v_mov_b32 v201, v190
    v_alignbit_b32 v203, v191, v190, 16
    v_mfma_f32_16x16x32_bf16 v[92:95], a[12:15], v[128:131], 0
    s_waitcnt vmcnt(8)
    v_alignbit_b32 v202, v190, v189, 16
    v_mfma_f32_16x16x32_bf16 v[80:83], a[16:19], v[132:135], v[80:83]
    buffer_load_dwordx4 v[128:131], v26, s[32:35], s62 offen sc1
    ds_write_b128 v43, v[64:67] offset:16384
    v_mfma_f32_16x16x32_bf16 v[84:87], a[20:23], v[132:135], v[84:87]
    v_mfma_f32_16x16x32_bf16 v[88:91], a[24:27], v[132:135], v[88:91]
    v_mfma_f32_16x16x32_bf16 v[92:95], a[28:31], v[132:135], v[92:95]
    s_waitcnt vmcnt(8)
    ds_write_b128 v43, v[68:71] offset:17408
    v_mfma_f32_16x16x32_bf16 v[80:83], a[32:35], v[96:99], v[80:83]
    buffer_load_dwordx4 v[132:135], v26, s[32:35], s63 offen sc1
    v_mfma_f32_16x16x32_bf16 v[84:87], a[36:39], v[96:99], v[84:87]
    v_mfma_f32_16x16x32_bf16 v[88:91], a[40:43], v[96:99], v[88:91]
    ds_write_b128 v43, v[72:75] offset:18432
    v_mfma_f32_16x16x32_bf16 v[92:95], a[44:47], v[96:99], v[92:95]
    s_waitcnt vmcnt(8)
    v_mfma_f32_16x16x32_bf16 v[80:83], a[48:51], v[100:103], v[80:83]
    buffer_load_dwordx4 v[96:99], v26, s[32:35], s64 offen sc1
    v_mfma_f32_16x16x32_bf16 v[84:87], a[52:55], v[100:103], v[84:87]
    v_mfma_f32_16x16x32_bf16 v[88:91], a[56:59], v[100:103], v[88:91]
    ds_write_b128 v43, v[76:79] offset:19456
    v_mfma_f32_16x16x32_bf16 v[92:95], a[60:63], v[100:103], v[92:95]
    s_waitcnt vmcnt(8)
    v_mfma_f32_16x16x32_bf16 v[80:83], a[64:67], v[104:107], v[80:83]
    buffer_load_dwordx4 v[100:103], v26, s[32:35], s65 offen sc1
    v_mfma_f32_16x16x32_bf16 v[84:87], a[68:71], v[104:107], v[84:87]
    ds_write_b128 v241, v[200:203] offset:35088
    v_alignbit_b32 v191, v190, v189, 16
    v_mfma_f32_16x16x32_bf16 v[88:91], a[72:75], v[104:107], v[88:91]
    s_waitcnt lgkmcnt(1)
    s_barrier
    s_lshl_b32 s76, s51, 4
    s_add_u32 s76, s76, 4096
    s_cmp_eq_u32 s50, 0
    s_cbranch_scc0 L_nokvflag
    s_mov_b64 exec, 3
    buffer_store_dwordx2 v[4:5], v47, s[32:35], s76 offen sc1
    s_mov_b64 exec, -1
L_nokvflag:
    v_alignbit_b32 v190, v189, v188, 16
    v_mfma_f32_16x16x32_bf16 v[92:95], a[76:79], v[104:107], v[92:95]
    s_waitcnt vmcnt(8)
    v_mfma_f32_16x16x32_bf16 v[80:83], a[80:83], v[108:111], v[80:83]
    buffer_load_dwordx4 v[104:107], v26, s[32:35], s66 offen sc1
    ds_write_b128 v241, v[188:191] offset:35072
    v_mfma_f32_16x16x32_bf16 v[84:87], a[84:87], v[108:111], v[84:87]
    s_mul_i32 s76, s50, 4608
    s_add_u32 s76, s76, 147840
    v_lshl_add_u32 v13, v1, 3, s76
    v_mov_b32 v36, 0
    v_mov_b32 v37, 0
    ds_write_b64 v13, v[36:37]
    v_mfma_f32_16x16x32_bf16 v[88:91], a[88:91], v[108:111], v[88:91]
    v_mfma_f32_16x16x32_bf16 v[92:95], a[92:95], v[108:111], v[92:95]
    s_waitcnt vmcnt(8)
    ds_read_b128 v[136:139], v40 offset:16384
    v_mfma_f32_16x16x32_bf16 v[80:83], a[96:99], v[112:115], v[80:83]
    buffer_load_dwordx4 v[108:111], v26, s[32:35], s67 offen sc1
    ds_read_b128 v[140:143], v40 offset:17408
    v_mfma_f32_16x16x32_bf16 v[84:87], a[100:103], v[112:115], v[84:87]
    ds_read_b128 v[144:147], v40 offset:18432
    v_mfma_f32_16x16x32_bf16 v[88:91], a[104:107], v[112:115], v[88:91]
    ds_read_b128 v[148:151], v40 offset:19456
    v_mfma_f32_16x16x32_bf16 v[92:95], a[108:111], v[112:115], v[92:95]
    s_waitcnt vmcnt(8)
    ds_read_b64 v[28:29], v10 offset:0
    v_mfma_f32_16x16x32_bf16 v[80:83], a[112:115], v[116:119], v[80:83]
    buffer_load_dwordx4 v[112:115], v27, s[32:35], s60 offen sc1
    ds_read_b64 v[30:31], v10 offset:32
    v_mfma_f32_16x16x32_bf16 v[84:87], a[116:119], v[116:119], v[84:87]
    s_waitcnt lgkmcnt(2)
    ds_read_b64 v[32:33], v10 offset:64
    v_mfma_f32_16x16x32_bf16 v[88:91], a[120:123], v[116:119], v[88:91]
    ds_read_b64 v[34:35], v10 offset:96
    v_mfma_f32_16x16x32_bf16 v[92:95], a[124:127], v[116:119], v[92:95]
    s_waitcnt vmcnt(8)
    s_waitcnt lgkmcnt(0)
    v_lshlrev_b32 v208, 16, v28
    v_and_b32 v209, 0xffff0000, v28
    v_mfma_f32_16x16x32_bf16 v[64:67], a[0:3], v[120:123], 0
    buffer_load_dwordx4 v[116:119], v27, s[32:35], s61 offen sc1
    v_lshlrev_b32 v210, 16, v29
    v_mfma_f32_16x16x32_bf16 v[68:71], a[4:7], v[120:123], 0
    v_and_b32 v211, 0xffff0000, v29
    v_lshlrev_b32 v212, 16, v30
    v_mfma_f32_16x16x32_bf16 v[72:75], a[8:11], v[120:123], 0
    v_and_b32 v213, 0xffff0000, v30
    v_lshlrev_b32 v214, 16, v31
    v_mfma_f32_16x16x32_bf16 v[76:79], a[12:15], v[120:123], 0
    s_waitcnt vmcnt(8)
    v_and_b32 v215, 0xffff0000, v31
    v_lshlrev_b32 v216, 16, v32
    v_mfma_f32_16x16x32_bf16 v[64:67], a[16:19], v[124:127], v[64:67]
    buffer_load_dwordx4 v[120:123], v27, s[32:35], s62 offen sc1
    ds_write_b128 v43, v[80:83] offset:20480
    v_mfma_f32_16x16x32_bf16 v[68:71], a[20:23], v[124:127], v[68:71]
    v_and_b32 v217, 0xffff0000, v32
    v_lshlrev_b32 v218, 16, v33
    v_mfma_f32_16x16x32_bf16 v[72:75], a[24:27], v[124:127], v[72:75]
    ds_write_b128 v43, v[84:87] offset:21504
    v_and_b32 v219, 0xffff0000, v33
    v_mfma_f32_16x16x32_bf16 v[76:79], a[28:31], v[124:127], v[76:79]
    s_waitcnt vmcnt(8)
    v_lshlrev_b32 v220, 16, v34
    v_and_b32 v221, 0xffff0000, v34
    v_mfma_f32_16x16x32_bf16 v[64:67], a[32:35], v[128:131], v[64:67]
    buffer_load_dwordx4 v[124:127], v27, s[32:35], s63 offen sc1
    v_lshlrev_b32 v222, 16, v35
    v_mfma_f32_16x16x32_bf16 v[68:71], a[36:39], v[128:131], v[68:71]
    v_and_b32 v223, 0xffff0000, v35
    s_mov_b32 s16, 0xbdd2d3e8
    v_mfma_f32_16x16x32_bf16 v[72:75], a[40:43], v[128:131], v[72:75]
    ds_write_b128 v43, v[88:91] offset:22528
    s_mov_b32 s17, 0xbdd2d3e8
    v_mfma_f32_16x16x32_bf16 v[76:79], a[44:47], v[128:131], v[76:79]
    s_waitcnt vmcnt(8)
    v_mov_b32 v50, 0xc0135761
    v_mov_b32 v51, 0xc0135761
    v_mfma_f32_16x16x32_bf16 v[64:67], a[48:51], v[132:135], v[64:67]
    buffer_load_dwordx4 v[128:131], v27, s[32:35], s64 offen sc1
    v_lshlrev_b32 v246, 16, v246
    v_mfma_f32_16x16x32_bf16 v[68:71], a[52:55], v[132:135], v[68:71]
    ds_write_b128 v43, v[92:95] offset:23552
    v_lshlrev_b32 v247, 16, v247
    v_mfma_f32_16x16x32_bf16 v[72:75], a[56:59], v[132:135], v[72:75]
    v_add_f32 v246, v246, v247
    v_cvt_pk_bf16_f32 v246, v246, v246
    v_mfma_f32_16x16x32_bf16 v[76:79], a[60:63], v[132:135], v[76:79]
    s_waitcnt vmcnt(8)
    v_lshrrev_b32 v10, 2, v1
    v_min_u32 v10, 2, v10
    v_mfma_f32_16x16x32_bf16 v[64:67], a[64:67], v[96:99], v[64:67]
    buffer_load_dwordx4 v[132:135], v27, s[32:35], s65 offen sc1
    v_mul_u32_u24 v10, 16512, v10
    v_mfma_f32_16x16x32_bf16 v[68:71], a[68:71], v[96:99], v[68:71]
    s_waitcnt lgkmcnt(0)
    s_barrier
    ds_read_b128 v[152:155], v41 offset:20480
    v_mfma_f32_16x16x32_bf16 v[72:75], a[72:75], v[96:99], v[72:75]
    ds_read_b128 v[156:159], v41 offset:21504
    v_and_b32 v11, 3, v1
    v_mfma_f32_16x16x32_bf16 v[76:79], a[76:79], v[96:99], v[76:79]
    s_waitcnt vmcnt(8)
    ds_read_b128 v[160:163], v41 offset:22528
    v_mul_u32_u24 v11, 6, v11
    v_mfma_f32_16x16x32_bf16 v[64:67], a[80:83], v[100:103], v[64:67]
    buffer_load_dwordx4 v[96:99], v27, s[32:35], s66 offen sc1
    ds_read_b128 v[164:167], v41 offset:23552
    v_mfma_f32_16x16x32_bf16 v[68:71], a[84:87], v[100:103], v[68:71]
    v_sub_u32 v10, v10, v11
    v_add_u32 v247, 98432, v10
    v_mfma_f32_16x16x32_bf16 v[72:75], a[88:91], v[100:103], v[72:75]
    s_lshl_b32 s98, s55, 2
    s_add_u32 s98, s98, s50
    s_lshl_b32 s98, s98, 4
    v_mfma_f32_16x16x32_bf16 v[76:79], a[92:95], v[100:103], v[76:79]
    s_waitcnt vmcnt(8)
    v_add_u32 v10, s98, v3
    v_lshlrev_b32 v11, 1, v10
    v_mfma_f32_16x16x32_bf16 v[64:67], a[96:99], v[104:107], v[64:67]
    s_waitcnt lgkmcnt(0)
    buffer_load_dwordx4 v[100:103], v27, s[32:35], s67 offen sc1
    v_add_f32 v136, v136, v152
    v_mfma_f32_16x16x32_bf16 v[68:71], a[100:103], v[104:107], v[68:71]
    v_add_f32 v137, v137, v153
    v_add_f32 v138, v138, v154
    v_mfma_f32_16x16x32_bf16 v[72:75], a[104:107], v[104:107], v[72:75]
    v_add_f32 v139, v139, v155
    v_add_f32 v140, v140, v156
    v_mfma_f32_16x16x32_bf16 v[76:79], a[108:111], v[104:107], v[76:79]
    s_waitcnt vmcnt(8)
    v_add_f32 v141, v141, v157
    v_add_f32 v142, v142, v158
    v_mfma_f32_16x16x32_bf16 v[64:67], a[112:115], v[108:111], v[64:67]
    buffer_load_dwordx4 v[104:107], v24, s[32:35], s68 offen sc1
    v_add_f32 v143, v143, v159
    v_mfma_f32_16x16x32_bf16 v[68:71], a[116:119], v[108:111], v[68:71]
    v_add_f32 v144, v144, v160
    v_add_f32 v145, v145, v161
    v_mfma_f32_16x16x32_bf16 v[72:75], a[120:123], v[108:111], v[72:75]
    v_add_f32 v146, v146, v162
    v_add_f32 v147, v147, v163
    v_mfma_f32_16x16x32_bf16 v[76:79], a[124:127], v[108:111], v[76:79]
    s_waitcnt vmcnt(8)
    v_add_f32 v148, v148, v164
    v_add_f32 v149, v149, v165
    v_mfma_f32_16x16x32_bf16 v[80:83], a[0:3], v[112:115], 0
    buffer_load_dwordx4 v[108:111], v24, s[32:35], s69 offen sc1
    v_add_f32 v150, v150, v166
    v_mfma_f32_16x16x32_bf16 v[84:87], a[4:7], v[112:115], 0
    v_add_f32 v151, v151, v167
    v_lshlrev_b32 v56, 2, v10
    v_mfma_f32_16x16x32_bf16 v[88:91], a[8:11], v[112:115], 0
    v_add_u32 v56, 98304, v56
    v_mfma_f32_16x16x32_bf16 v[92:95], a[12:15], v[112:115], 0
    s_waitcnt vmcnt(8)
    global_load_ushort v62, v11, s[24:25]
    s_mul_i32 s98, s98, 1280
    s_mul_i32 s99, s54, 160
    v_mfma_f32_16x16x32_bf16 v[80:83], a[16:19], v[116:119], v[80:83]
    buffer_load_dwordx4 v[112:115], v24, s[32:35], s70 offen sc1
    ds_write_b128 v43, v[64:67] offset:16384
    v_mfma_f32_16x16x32_bf16 v[84:87], a[20:23], v[116:119], v[84:87]
    s_add_u32 s98, s98, s99
    v_lshrrev_b32 v10, 3, v1
    v_mul_u32_u24 v10, 1280, v10
    v_mfma_f32_16x16x32_bf16 v[88:91], a[24:27], v[116:119], v[88:91]
    ds_write_b128 v43, v[68:71] offset:17408
    v_and_b32 v11, 7, v1
    v_mfma_f32_16x16x32_bf16 v[92:95], a[28:31], v[116:119], v[92:95]
    s_waitcnt vmcnt(9)
    v_xor_b32 v11, v11, v2
    v_add_u32 v10, s98, v10
    v_mfma_f32_16x16x32_bf16 v[80:83], a[32:35], v[120:123], v[80:83]
    buffer_load_dwordx4 v[116:119], v24, s[32:35], s71 offen sc1
    v_lshl_add_u32 v16, v11, 4, v10
    v_mfma_f32_16x16x32_bf16 v[84:87], a[36:39], v[120:123], v[84:87]
    v_xor_b32 v11, 4, v11
    v_lshl_add_u32 v17, v11, 4, v10
    v_mfma_f32_16x16x32_bf16 v[88:91], a[40:43], v[120:123], v[88:91]
    ds_write_b128 v43, v[72:75] offset:18432
    v_add_u32 v17, 10240, v17
    v_mfma_f32_16x16x32_bf16 v[92:95], a[44:47], v[120:123], v[92:95]
    s_waitcnt vmcnt(9)
    v_lshrrev_b32 v10, 1, v1
    v_mul_u32_u24 v10, 1280, v10
    v_mfma_f32_16x16x32_bf16 v[80:83], a[48:51], v[124:127], v[80:83]
    buffer_load_dwordx4 v[120:123], v24, s[32:35], s72 offen sc1
    v_and_b32 v11, 1, v1
    v_mfma_f32_16x16x32_bf16 v[84:87], a[52:55], v[124:127], v[84:87]
    ds_write_b128 v43, v[76:79] offset:19456
    v_lshl_add_u32 v10, v11, 4, v10
    v_mfma_f32_16x16x32_bf16 v[88:91], a[56:59], v[124:127], v[88:91]
    s_add_u32 s98, s98, 128
    v_lshlrev_b32 v11, 25, v1
    v_add_u32 v10, s98, v10
    v_mfma_f32_16x16x32_bf16 v[92:95], a[60:63], v[124:127], v[92:95]
    s_waitcnt vmcnt(9)
    v_and_or_b32 v18, v11, 2.0, v10
    s_add_u32 s98, s59, 20480
    v_mfma_f32_16x16x32_bf16 v[80:83], a[64:67], v[128:131], v[80:83]
    buffer_load_dwordx4 v[124:127], v24, s[32:35], s73 offen sc1
    v_lshrrev_b32 v10, 1, v3
    v_mfma_f32_16x16x32_bf16 v[84:87], a[68:71], v[128:131], v[84:87]
    s_waitcnt lgkmcnt(0)
    s_barrier
    ds_read_b128 v[152:155], v42 offset:16384
    v_mfma_f32_16x16x32_bf16 v[88:91], a[72:75], v[128:131], v[88:91]
    ds_read_b128 v[156:159], v42 offset:17408
    v_lshrrev_b32 v11, 1, v2
    v_mfma_f32_16x16x32_bf16 v[92:95], a[76:79], v[128:131], v[92:95]
    s_waitcnt vmcnt(9)
    ds_read_b128 v[160:163], v42 offset:18432
    v_xor_b32 v10, v10, v11
    v_mfma_f32_16x16x32_bf16 v[80:83], a[80:83], v[132:135], v[80:83]
    buffer_load_dwordx4 v[128:131], v24, s[32:35], s74 offen sc1
    ds_read_b128 v[164:167], v42 offset:19456
    v_mfma_f32_16x16x32_bf16 v[84:87], a[84:87], v[132:135], v[84:87]
    v_lshlrev_b32 v10, 4, v10
    v_lshl_add_u32 v10, v3, 7, v10
    v_mfma_f32_16x16x32_bf16 v[88:91], a[88:91], v[132:135], v[88:91]
    v_and_b32 v11, 1, v2
    v_lshl_add_u32 v10, v11, 3, v10
    v_mfma_f32_16x16x32_bf16 v[92:95], a[92:95], v[132:135], v[92:95]
    s_waitcnt vmcnt(9)
    v_add_u32 v19, s98, v10
    v_xor_b32 v20, 32, v19
    v_mfma_f32_16x16x32_bf16 v[80:83], a[96:99], v[96:99], v[80:83]
    s_waitcnt lgkmcnt(0)
    buffer_load_dwordx4 v[132:135], v24, s[32:35], s75 offen sc1
    v_add_f32 v136, v136, v152
    v_mfma_f32_16x16x32_bf16 v[84:87], a[100:103], v[96:99], v[84:87]
    v_add_f32 v137, v137, v153
    v_add_f32 v138, v138, v154
    v_mfma_f32_16x16x32_bf16 v[88:91], a[104:107], v[96:99], v[88:91]
    v_add_f32 v139, v139, v155
    v_add_f32 v140, v140, v156
    v_mfma_f32_16x16x32_bf16 v[92:95], a[108:111], v[96:99], v[92:95]
    s_waitcnt vmcnt(9)
    v_add_f32 v141, v141, v157
    v_add_f32 v142, v142, v158
    v_mfma_f32_16x16x32_bf16 v[80:83], a[112:115], v[100:103], v[80:83]
    buffer_load_dwordx4 v[96:99], v25, s[32:35], s68 offen sc1
    v_add_f32 v143, v143, v159
    v_mfma_f32_16x16x32_bf16 v[84:87], a[116:119], v[100:103], v[84:87]
    v_add_f32 v144, v144, v160
    v_add_f32 v145, v145, v161
    v_mfma_f32_16x16x32_bf16 v[88:91], a[120:123], v[100:103], v[88:91]
    v_add_f32 v146, v146, v162
    v_add_f32 v147, v147, v163
    v_mfma_f32_16x16x32_bf16 v[92:95], a[124:127], v[100:103], v[92:95]
    s_waitcnt vmcnt(9)
    v_add_f32 v148, v148, v164
    v_add_f32 v149, v149, v165
    v_mfma_f32_16x16x32_bf16 v[64:67], a[0:3], v[104:107], 0
    buffer_load_dwordx4 v[100:103], v25, s[32:35], s69 offen sc1
    v_add_f32 v150, v150, v166
    v_mfma_f32_16x16x32_bf16 v[68:71], a[4:7], v[104:107], 0
    v_add_f32 v151, v151, v167
    v_xor_b32 v21, 64, v19
    v_mfma_f32_16x16x32_bf16 v[72:75], a[8:11], v[104:107], 0
    v_xor_b32 v22, 0x60, v19
    v_lshl_add_u32 v10, v3, 5, s98
    v_mfma_f32_16x16x32_bf16 v[76:79], a[12:15], v[104:107], 0
    s_waitcnt vmcnt(9)
    v_lshl_add_u32 v23, v2, 3, v10
    v_bfe_u32 v10, v1, 4, 1
    v_mfma_f32_16x16x32_bf16 v[64:67], a[16:19], v[108:111], v[64:67]
    buffer_load_dwordx4 v[104:107], v25, s[32:35], s70 offen sc1
    v_add_f32 v136, v136, v80
    v_mfma_f32_16x16x32_bf16 v[68:71], a[20:23], v[108:111], v[68:71]
    v_add_f32 v137, v137, v81
    v_cvt_pk_bf16_f32 v152, v136, v137
    v_mfma_f32_16x16x32_bf16 v[72:75], a[24:27], v[108:111], v[72:75]
    v_add_f32 v138, v138, v82
    v_add_f32 v139, v139, v83
    v_mfma_f32_16x16x32_bf16 v[76:79], a[28:31], v[108:111], v[76:79]
    s_waitcnt vmcnt(8)
    v_cvt_pk_bf16_f32 v153, v138, v139
    v_add_f32 v140, v140, v84
    v_mfma_f32_16x16x32_bf16 v[64:67], a[32:35], v[112:115], v[64:67]
    buffer_load_dwordx4 v[108:111], v25, s[32:35], s71 offen sc1
    v_add_f32 v141, v141, v85
    v_mfma_f32_16x16x32_bf16 v[68:71], a[36:39], v[112:115], v[68:71]
    v_cvt_pk_bf16_f32 v154, v140, v141
    v_add_f32 v142, v142, v86
    v_mfma_f32_16x16x32_bf16 v[72:75], a[40:43], v[112:115], v[72:75]
    v_add_f32 v143, v143, v87
    v_cvt_pk_bf16_f32 v155, v142, v143
    v_mfma_f32_16x16x32_bf16 v[76:79], a[44:47], v[112:115], v[76:79]
    s_waitcnt vmcnt(8)
    buffer_store_dwordx4 v[152:155], v243, s[32:35], 0 offen offset:0 sc1
    v_add3_u32 v160, v152, v153, v4
    v_mfma_f32_16x16x32_bf16 v[64:67], a[48:51], v[116:119], v[64:67]
    buffer_load_dwordx4 v[112:115], v25, s[32:35], s72 offen sc1
    v_lshl_add_u32 v160, v154, 1, v160
    v_mfma_f32_16x16x32_bf16 v[68:71], a[52:55], v[116:119], v[68:71]
    v_add_f32 v144, v144, v88
    v_add_f32 v145, v145, v89
    v_mfma_f32_16x16x32_bf16 v[72:75], a[56:59], v[116:119], v[72:75]
    v_cvt_pk_bf16_f32 v156, v144, v145
    v_add_f32 v146, v146, v90
    v_mfma_f32_16x16x32_bf16 v[76:79], a[60:63], v[116:119], v[76:79]
    s_waitcnt vmcnt(9)
    v_add_f32 v147, v147, v91
    v_cvt_pk_bf16_f32 v157, v146, v147
    v_mfma_f32_16x16x32_bf16 v[64:67], a[64:67], v[120:123], v[64:67]
    buffer_load_dwordx4 v[116:119], v25, s[32:35], s73 offen sc1
    v_add_f32 v148, v148, v92
    v_mfma_f32_16x16x32_bf16 v[68:71], a[68:71], v[120:123], v[68:71]
    v_add_f32 v149, v149, v93
    v_cvt_pk_bf16_f32 v158, v148, v149
    v_mfma_f32_16x16x32_bf16 v[72:75], a[72:75], v[120:123], v[72:75]
    v_add_f32 v150, v150, v94
    v_add_f32 v151, v151, v95
    v_mfma_f32_16x16x32_bf16 v[76:79], a[76:79], v[120:123], v[76:79]
    s_waitcnt vmcnt(9)
    v_cvt_pk_bf16_f32 v159, v150, v151
    v_lshlrev_b32 v10, 7, v10
    v_mfma_f32_16x16x32_bf16 v[64:67], a[80:83], v[124:127], v[64:67]
    buffer_load_dwordx4 v[120:123], v25, s[32:35], s74 offen sc1
    v_add_u32 v10, v10, v3
    v_mfma_f32_16x16x32_bf16 v[68:71], a[84:87], v[124:127], v[68:71]
    buffer_store_dwordx4 v[156:159], v243, s[32:35], 0 offen offset:1024 sc1
    s_lshl_b32 s98, s54, 8
    s_add_u32 s98, s98, 36864
    v_mfma_f32_16x16x32_bf16 v[72:75], a[88:91], v[124:127], v[72:75]
    v_add3_u32 v160, v155, v156, v160
    v_lshl_add_u32 v160, v158, 1, v160
    v_mfma_f32_16x16x32_bf16 v[76:79], a[92:95], v[124:127], v[76:79]
    s_waitcnt vmcnt(10)
    v_add3_u32 v160, v157, v159, v160
    v_lshl_add_u32 v38, v10, 4, s98
    v_mfma_f32_16x16x32_bf16 v[64:67], a[96:99], v[128:131], v[64:67]
    buffer_load_dwordx4 v[124:127], v25, s[32:35], s75 offen sc1
    v_lshrrev_b32 v10, 3, v0
    v_mfma_f32_16x16x32_bf16 v[68:71], a[100:103], v[128:131], v[68:71]
    buffer_store_dword v160, v205, s[32:35], 0 offen offset:2048 sc1
    s_mul_i32 s98, s54, 80
    v_add_u32 v10, s98, v10
    v_mfma_f32_16x16x32_bf16 v[72:75], a[104:107], v[128:131], v[72:75]
    v_lshlrev_b32 v10, 12, v10
    v_and_b32 v11, 7, v1
    v_mfma_f32_16x16x32_bf16 v[76:79], a[108:111], v[128:131], v[76:79]
    s_waitcnt vmcnt(11)
    v_lshlrev_b32 v12, 1, v2
    v_xor_b32 v11, v11, v12
    v_mfma_f32_16x16x32_bf16 v[64:67], a[112:115], v[132:135], v[64:67]
    buffer_load_dwordx4 v[128:131], v26, s[32:35], s68 offen sc1
    v_lshl_add_u32 v10, v11, 4, v10
    v_mfma_f32_16x16x32_bf16 v[68:71], a[116:119], v[132:135], v[68:71]
    s_lshl_b32 s99, s55, 7
    s_add_u32 s99, s99, 7471104
    v_add_u32 v32, s99, v10
    v_mfma_f32_16x16x32_bf16 v[72:75], a[120:123], v[132:135], v[72:75]
    v_add_u32 v33, 131072, v32
    s_cmp_lt_u32 s50, 2
    s_cselect_b32 s99, 262144, s94
    v_mfma_f32_16x16x32_bf16 v[76:79], a[124:127], v[132:135], v[76:79]
    s_waitcnt vmcnt(11)
    v_add_u32 v34, s99, v32
    v_bfe_u32 v10, v1, 2, 3
    v_mfma_f32_16x16x32_bf16 v[80:83], a[0:3], v[96:99], 0
    buffer_load_dwordx4 v[132:135], v26, s[32:35], s69 offen sc1
    v_lshlrev_b32 v10, 7, v10
    v_mfma_f32_16x16x32_bf16 v[84:87], a[4:7], v[96:99], 0
    v_and_b32 v11, 3, v3
    v_lshl_add_u32 v10, v11, 3, v10
    v_mfma_f32_16x16x32_bf16 v[88:91], a[8:11], v[96:99], 0
    v_bfe_u32 v11, v1, 3, 2
    v_xor_b32 v11, s50, v11
    v_mfma_f32_16x16x32_bf16 v[92:95], a[12:15], v[96:99], 0
    s_waitcnt vmcnt(11)
    v_lshl_add_u32 v10, v11, 5, v10
    v_lshrrev_b32 v11, 1, v2
    v_mul_u32_u24 v11, 24576, v11
    v_add_u32 v10, v10, v11
    v_add_u32 v35, 16384, v10
    s_mov_b32 s60, s4
    s_and_b32 s61, s5, 0xffff
    s_mov_b32 s62, 2621440
    s_mov_b32 s63, 0x20000
    s_mov_b32 s64, s28
    s_and_b32 s65, s29, 0xffff
    s_mov_b32 s66, 2621440
    s_mov_b32 s67, 0x20000
    v_mfma_f32_16x16x32_bf16 v[80:83], a[16:19], v[100:103], v[80:83]
    buffer_load_dwordx4 v[96:99], v26, s[32:35], s70 offen sc1
    ds_write_b128 v43, v[64:67] offset:20480
    v_mfma_f32_16x16x32_bf16 v[84:87], a[20:23], v[100:103], v[84:87]
    v_mfma_f32_16x16x32_bf16 v[88:91], a[24:27], v[100:103], v[88:91]
    ds_write_b128 v43, v[68:71] offset:21504
    v_mfma_f32_16x16x32_bf16 v[92:95], a[28:31], v[100:103], v[92:95]
    s_waitcnt vmcnt(11)
    v_mfma_f32_16x16x32_bf16 v[80:83], a[32:35], v[104:107], v[80:83]
    buffer_load_dwordx4 v[100:103], v26, s[32:35], s71 offen sc1
    v_mfma_f32_16x16x32_bf16 v[84:87], a[36:39], v[104:107], v[84:87]
    v_mfma_f32_16x16x32_bf16 v[88:91], a[40:43], v[104:107], v[88:91]
    ds_write_b128 v43, v[72:75] offset:22528
    v_mfma_f32_16x16x32_bf16 v[92:95], a[44:47], v[104:107], v[92:95]
    s_waitcnt vmcnt(11)
    v_mfma_f32_16x16x32_bf16 v[80:83], a[48:51], v[108:111], v[80:83]
    buffer_load_dwordx4 v[104:107], v26, s[32:35], s72 offen sc1
    v_mfma_f32_16x16x32_bf16 v[84:87], a[52:55], v[108:111], v[84:87]
    ds_write_b128 v43, v[76:79] offset:23552
    v_mfma_f32_16x16x32_bf16 v[88:91], a[56:59], v[108:111], v[88:91]
    v_mfma_f32_16x16x32_bf16 v[92:95], a[60:63], v[108:111], v[92:95]
    s_waitcnt vmcnt(10)
    v_mfma_f32_16x16x32_bf16 v[80:83], a[64:67], v[112:115], v[80:83]
    buffer_load_dwordx4 v[108:111], v26, s[32:35], s73 offen sc1
    v_mfma_f32_16x16x32_bf16 v[84:87], a[68:71], v[112:115], v[84:87]
    s_waitcnt lgkmcnt(0)
    s_barrier
    ds_write_b16 v247, v246
    v_mfma_f32_16x16x32_bf16 v[88:91], a[72:75], v[112:115], v[88:91]
    buffer_load_dwordx2 v[36:37], v46, s[32:35], 0 offen sc1
    ds_read_b128 v[152:155], v40 offset:20480
    v_mfma_f32_16x16x32_bf16 v[92:95], a[76:79], v[112:115], v[92:95]
    s_waitcnt vmcnt(11)
    ds_read_b128 v[156:159], v40 offset:21504
    v_mfma_f32_16x16x32_bf16 v[80:83], a[80:83], v[116:119], v[80:83]
    buffer_load_dwordx4 v[112:115], v26, s[32:35], s74 offen sc1
    ds_read_b128 v[160:163], v40 offset:22528
    v_mfma_f32_16x16x32_bf16 v[84:87], a[84:87], v[116:119], v[84:87]
    ds_read_b128 v[164:167], v40 offset:23552
    v_mfma_f32_16x16x32_bf16 v[88:91], a[88:91], v[116:119], v[88:91]
    v_mfma_f32_16x16x32_bf16 v[92:95], a[92:95], v[116:119], v[92:95]
    s_waitcnt vmcnt(11)
    v_mfma_f32_16x16x32_bf16 v[80:83], a[96:99], v[120:123], v[80:83]
    s_waitcnt lgkmcnt(0)
    buffer_load_dwordx4 v[116:119], v26, s[32:35], s75 offen sc1
    v_add_f32 v208, v208, v152
    v_mfma_f32_16x16x32_bf16 v[84:87], a[100:103], v[120:123], v[84:87]
    v_add_f32 v209, v209, v153
    v_add_f32 v210, v210, v154
    v_mfma_f32_16x16x32_bf16 v[88:91], a[104:107], v[120:123], v[88:91]
    v_add_f32 v211, v211, v155
    v_add_f32 v212, v212, v156
    v_mfma_f32_16x16x32_bf16 v[92:95], a[108:111], v[120:123], v[92:95]
    s_waitcnt vmcnt(10)
    v_add_f32 v213, v213, v157
    v_add_f32 v214, v214, v158
    v_mfma_f32_16x16x32_bf16 v[80:83], a[112:115], v[124:127], v[80:83]
    buffer_load_dwordx4 v[120:123], v27, s[32:35], s68 offen sc1
    v_add_f32 v215, v215, v159
    v_mfma_f32_16x16x32_bf16 v[84:87], a[116:119], v[124:127], v[84:87]
    v_add_f32 v216, v216, v160
    v_add_f32 v217, v217, v161
    v_mfma_f32_16x16x32_bf16 v[88:91], a[120:123], v[124:127], v[88:91]
    v_add_f32 v218, v218, v162
    v_add_f32 v219, v219, v163
    v_mfma_f32_16x16x32_bf16 v[92:95], a[124:127], v[124:127], v[92:95]
    s_waitcnt vmcnt(9)
    v_add_f32 v220, v220, v164
    v_add_f32 v221, v221, v165
    v_mfma_f32_16x16x32_bf16 v[64:67], a[0:3], v[128:131], 0
    buffer_load_dwordx4 v[124:127], v27, s[32:35], s69 offen sc1
    v_add_f32 v222, v222, v166
    v_mfma_f32_16x16x32_bf16 v[68:71], a[4:7], v[128:131], 0
    v_add_f32 v223, v223, v167
    v_mfma_f32_16x16x32_bf16 v[72:75], a[8:11], v[128:131], 0
    v_mfma_f32_16x16x32_bf16 v[76:79], a[12:15], v[128:131], 0
    s_waitcnt vmcnt(9)
    v_mfma_f32_16x16x32_bf16 v[64:67], a[16:19], v[132:135], v[64:67]
    buffer_load_dwordx4 v[128:131], v27, s[32:35], s70 offen sc1
    ds_write_b128 v43, v[80:83] offset:16384
    v_mfma_f32_16x16x32_bf16 v[68:71], a[20:23], v[132:135], v[68:71]
    v_mfma_f32_16x16x32_bf16 v[72:75], a[24:27], v[132:135], v[72:75]
    ds_write_b128 v43, v[84:87] offset:17408
    v_mfma_f32_16x16x32_bf16 v[76:79], a[28:31], v[132:135], v[76:79]
    s_waitcnt vmcnt(9)
    v_mfma_f32_16x16x32_bf16 v[64:67], a[32:35], v[96:99], v[64:67]
    buffer_load_dwordx4 v[132:135], v27, s[32:35], s71 offen sc1
    v_mfma_f32_16x16x32_bf16 v[68:71], a[36:39], v[96:99], v[68:71]
    v_mfma_f32_16x16x32_bf16 v[72:75], a[40:43], v[96:99], v[72:75]
    ds_write_b128 v43, v[88:91] offset:18432
    v_mfma_f32_16x16x32_bf16 v[76:79], a[44:47], v[96:99], v[76:79]
    s_waitcnt vmcnt(9)
    v_mfma_f32_16x16x32_bf16 v[64:67], a[48:51], v[100:103], v[64:67]
    buffer_load_dwordx4 v[96:99], v27, s[32:35], s72 offen sc1
    v_mfma_f32_16x16x32_bf16 v[68:71], a[52:55], v[100:103], v[68:71]
    ds_write_b128 v43, v[92:95] offset:19456
    v_mfma_f32_16x16x32_bf16 v[72:75], a[56:59], v[100:103], v[72:75]
    v_mfma_f32_16x16x32_bf16 v[76:79], a[60:63], v[100:103], v[76:79]
    s_waitcnt vmcnt(9)
    v_mfma_f32_16x16x32_bf16 v[64:67], a[64:67], v[104:107], v[64:67]
    buffer_load_dwordx4 v[100:103], v27, s[32:35], s73 offen sc1
    v_mfma_f32_16x16x32_bf16 v[68:71], a[68:71], v[104:107], v[68:71]
    s_waitcnt lgkmcnt(0)
    s_barrier
    ds_read_b128 v[152:155], v41 offset:16384
    v_mfma_f32_16x16x32_bf16 v[72:75], a[72:75], v[104:107], v[72:75]
    ds_read_b128 v[156:159], v41 offset:17408
    v_mfma_f32_16x16x32_bf16 v[76:79], a[76:79], v[104:107], v[76:79]
    s_waitcnt vmcnt(9)
    ds_read_b128 v[160:163], v41 offset:18432
    v_mfma_f32_16x16x32_bf16 v[64:67], a[80:83], v[108:111], v[64:67]
    buffer_load_dwordx4 v[104:107], v27, s[32:35], s74 offen sc1
    ds_read_b128 v[164:167], v41 offset:19456
    v_mfma_f32_16x16x32_bf16 v[68:71], a[84:87], v[108:111], v[68:71]
    v_mfma_f32_16x16x32_bf16 v[72:75], a[88:91], v[108:111], v[72:75]
    buffer_load_dwordx4 v[168:171], v244, s[32:35], 0 offen offset:0 sc1
    v_mfma_f32_16x16x32_bf16 v[76:79], a[92:95], v[108:111], v[76:79]
    s_waitcnt vmcnt(9)
    v_mfma_f32_16x16x32_bf16 v[64:67], a[96:99], v[112:115], v[64:67]
    s_waitcnt lgkmcnt(0)
    buffer_load_dwordx4 v[108:111], v27, s[32:35], s75 offen sc1
    v_add_f32 v208, v208, v152
    v_mfma_f32_16x16x32_bf16 v[68:71], a[100:103], v[112:115], v[68:71]
    v_add_f32 v209, v209, v153
    v_add_f32 v210, v210, v154
    v_mfma_f32_16x16x32_bf16 v[72:75], a[104:107], v[112:115], v[72:75]
    buffer_load_dwordx4 v[172:175], v244, s[32:35], 0 offen offset:1024 sc1
    v_add_f32 v211, v211, v155
    v_mfma_f32_16x16x32_bf16 v[76:79], a[108:111], v[112:115], v[76:79]
    s_waitcnt vmcnt(10)
    v_add_f32 v212, v212, v156
    v_add_f32 v213, v213, v157
    v_mfma_f32_16x16x32_bf16 v[64:67], a[112:115], v[116:119], v[64:67]
    buffer_load_dword v176, v206, s[32:35], 0 offen offset:2048 sc1
    v_add_f32 v214, v214, v158
    v_mfma_f32_16x16x32_bf16 v[68:71], a[116:119], v[116:119], v[68:71]
    v_add_f32 v215, v215, v159
    v_add_f32 v216, v216, v160
    v_mfma_f32_16x16x32_bf16 v[72:75], a[120:123], v[116:119], v[72:75]
    v_add_f32 v217, v217, v161
    v_add_f32 v218, v218, v162
    v_mfma_f32_16x16x32_bf16 v[76:79], a[124:127], v[116:119], v[76:79]
    s_waitcnt vmcnt(10)
    v_add_f32 v219, v219, v163
    v_add_f32 v220, v220, v164
    v_cmp_ne_u64 vcc, s[48:49], v[36:37]
    s_cbranch_vccz L_pollkv_ok
    s_mov_b32 s3, 0
L_pollkv:
    s_mov_b64 exec, vcc
    buffer_load_dwordx2 v[36:37], v46, s[32:35], 0 offen sc1
    s_waitcnt vmcnt(0)
    v_cmp_ne_u64 vcc, s[48:49], v[36:37]
    s_add_u32 s3, s3, 1
    s_cbranch_vccz L_pollkv_out
    s_cmp_lt_u32 s3, 200000
    s_cbranch_scc1 L_pollkv
L_pollkv_out:
    s_mov_b64 exec, -1
L_pollkv_ok:
    v_add_f32 v221, v221, v165
    v_add_f32 v222, v222, v166
    v_add_f32 v223, v223, v167
    v_mfma_f32_16x16x32_bf16 v[80:83], a[0:3], v[120:123], v[208:211]
    v_mfma_f32_16x16x32_bf16 v[84:87], a[4:7], v[120:123], v[212:215]
    v_mfma_f32_16x16x32_bf16 v[88:91], a[8:11], v[120:123], v[216:219]
    s_mul_i32 s76, s7, 0
    buffer_load_dwordx4 v[224:227], v44, s[32:35], s76 offen sc1
    v_mfma_f32_16x16x32_bf16 v[92:95], a[12:15], v[120:123], v[220:223]
    s_waitcnt vmcnt(10)
    v_mfma_f32_16x16x32_bf16 v[80:83], a[16:19], v[124:127], v[80:83]
    ds_write_b128 v43, v[64:67] offset:20480
    v_mfma_f32_16x16x32_bf16 v[84:87], a[20:23], v[124:127], v[84:87]
    v_mfma_f32_16x16x32_bf16 v[88:91], a[24:27], v[124:127], v[88:91]
    s_mul_i32 s76, s7, 4
    buffer_load_dwordx4 v[228:231], v44, s[32:35], s76 offen sc1
    ds_write_b128 v43, v[68:71] offset:21504
    v_mfma_f32_16x16x32_bf16 v[92:95], a[28:31], v[124:127], v[92:95]
    s_waitcnt vmcnt(10)
    v_mfma_f32_16x16x32_bf16 v[80:83], a[32:35], v[128:131], v[80:83]
    v_mfma_f32_16x16x32_bf16 v[84:87], a[36:39], v[128:131], v[84:87]
    v_mfma_f32_16x16x32_bf16 v[88:91], a[40:43], v[128:131], v[88:91]
    s_mul_i32 s76, s7, 8
    buffer_load_dwordx4 v[232:235], v44, s[32:35], s76 offen sc1
    ds_write_b128 v43, v[72:75] offset:22528
    v_mfma_f32_16x16x32_bf16 v[92:95], a[44:47], v[128:131], v[92:95]
    s_waitcnt vmcnt(10)
    v_mfma_f32_16x16x32_bf16 v[80:83], a[48:51], v[132:135], v[80:83]
    v_mfma_f32_16x16x32_bf16 v[84:87], a[52:55], v[132:135], v[84:87]
    ds_write_b128 v43, v[76:79] offset:23552
    v_mfma_f32_16x16x32_bf16 v[88:91], a[56:59], v[132:135], v[88:91]
    s_mul_i32 s76, s7, 12
    buffer_load_dwordx4 v[236:239], v44, s[32:35], s76 offen sc1
    v_mfma_f32_16x16x32_bf16 v[92:95], a[60:63], v[132:135], v[92:95]
    s_waitcnt vmcnt(10)
    v_mfma_f32_16x16x32_bf16 v[80:83], a[64:67], v[96:99], v[80:83]
    v_mfma_f32_16x16x32_bf16 v[84:87], a[68:71], v[96:99], v[84:87]
    s_waitcnt lgkmcnt(0)
    s_barrier
    buffer_load_dword v56, v56, s[32:35], 0 offen sc1
    v_mfma_f32_16x16x32_bf16 v[88:91], a[72:75], v[96:99], v[88:91]
    ds_read_b128 v[152:155], v42 offset:20480
    v_mfma_f32_16x16x32_bf16 v[92:95], a[76:79], v[96:99], v[92:95]
    s_waitcnt vmcnt(10)
    ds_read_b128 v[156:159], v42 offset:21504
    v_mfma_f32_16x16x32_bf16 v[80:83], a[80:83], v[100:103], v[80:83]
    ds_read_b128 v[160:163], v42 offset:22528
    v_mfma_f32_16x16x32_bf16 v[84:87], a[84:87], v[100:103], v[84:87]
    ds_read_b128 v[164:167], v42 offset:23552
    v_mfma_f32_16x16x32_bf16 v[88:91], a[88:91], v[100:103], v[88:91]
    v_mfma_f32_16x16x32_bf16 v[92:95], a[92:95], v[100:103], v[92:95]
    s_waitcnt vmcnt(9)
    v_mfma_f32_16x16x32_bf16 v[80:83], a[96:99], v[104:107], v[80:83]
    v_mfma_f32_16x16x32_bf16 v[84:87], a[100:103], v[104:107], v[84:87]
    v_mfma_f32_16x16x32_bf16 v[88:91], a[104:107], v[104:107], v[88:91]
    v_mfma_f32_16x16x32_bf16 v[92:95], a[108:111], v[104:107], v[92:95]
    s_waitcnt vmcnt(7)
    v_mfma_f32_16x16x32_bf16 v[80:83], a[112:115], v[108:111], v[80:83]
    v_mfma_f32_16x16x32_bf16 v[84:87], a[116:119], v[108:111], v[84:87]
    v_mfma_f32_16x16x32_bf16 v[88:91], a[120:123], v[108:111], v[88:91]
    v_mfma_f32_16x16x32_bf16 v[92:95], a[124:127], v[108:111], v[92:95]
    s_waitcnt lgkmcnt(0)
    s_nop 3
    v_pk_add_f32 v[208:209], v[80:81], v[152:153]
    v_pk_add_f32 v[210:211], v[82:83], v[154:155]
    v_pk_add_f32 v[212:213], v[84:85], v[156:157]
    v_pk_add_f32 v[214:215], v[86:87], v[158:159]
    v_pk_add_f32 v[216:217], v[88:89], v[160:161]
    v_pk_add_f32 v[218:219], v[90:91], v[162:163]
    v_pk_add_f32 v[220:221], v[92:93], v[164:165]
    v_pk_add_f32 v[222:223], v[94:95], v[166:167]
    s_mov_b32 s3, 0
    s_waitcnt vmcnt(5)
L_px:
    v_add3_u32 v10, v168, v169, v4
    v_lshl_add_u32 v10, v170, 1, v10
    v_add3_u32 v10, v171, v172, v10
    v_lshl_add_u32 v10, v174, 1, v10
    v_add3_u32 v10, v173, v175, v10
    v_xor_b32 v10, v10, v176
    v_and_b32 v10, s58, v10
    v_cmp_ne_u32 vcc, 0, v10
    s_cbranch_vccz L_px_ok
    buffer_load_dwordx4 v[168:171], v244, s[32:35], 0 offen offset:0 sc1
    buffer_load_dwordx4 v[172:175], v244, s[32:35], 0 offen offset:1024 sc1
    buffer_load_dword v176, v206, s[32:35], 0 offen offset:2048 sc1
    s_add_u32 s3, s3, 1
    s_cmp_lt_u32 s3, 200000
    s_waitcnt vmcnt(0)
    s_cbranch_scc1 L_px
L_px_ok:
    v_lshlrev_b32 v188, 16, v168
    v_and_b32 v189, 0xffff0000, v168
    v_pk_add_f32 v[208:209], v[208:209], v[188:189]
    v_lshlrev_b32 v190, 16, v169
    v_and_b32 v191, 0xffff0000, v169
    v_pk_add_f32 v[210:211], v[210:211], v[190:191]
    v_lshlrev_b32 v192, 16, v170
    v_and_b32 v193, 0xffff0000, v170
    v_pk_add_f32 v[212:213], v[212:213], v[192:193]
    v_lshlrev_b32 v194, 16, v171
    v_and_b32 v195, 0xffff0000, v171
    v_pk_add_f32 v[214:215], v[214:215], v[194:195]
    v_lshlrev_b32 v196, 16, v172
    v_and_b32 v197, 0xffff0000, v172
    v_pk_add_f32 v[216:217], v[216:217], v[196:197]
    v_lshlrev_b32 v198, 16, v173
    v_and_b32 v199, 0xffff0000, v173
    v_pk_add_f32 v[218:219], v[218:219], v[198:199]
    v_lshlrev_b32 v200, 16, v174
    v_and_b32 v201, 0xffff0000, v174
    v_pk_add_f32 v[220:221], v[220:221], v[200:201]
    v_lshlrev_b32 v202, 16, v175
    v_and_b32 v203, 0xffff0000, v175
    v_pk_add_f32 v[222:223], v[222:223], v[202:203]
    v_pk_mul_f32 v[188:189], v[208:209], v[208:209]
    v_pk_mul_f32 v[190:191], v[210:211], v[210:211]
    v_pk_mul_f32 v[192:193], v[212:213], v[212:213]
    v_pk_mul_f32 v[194:195], v[214:215], v[214:215]
    v_pk_fma_f32 v[188:189], v[188:189], s[16:17], v[50:51]
    v_pk_fma_f32 v[190:191], v[190:191], s[16:17], v[50:51]
    v_pk_fma_f32 v[192:193], v[192:193], s[16:17], v[50:51]
    v_pk_fma_f32 v[194:195], v[194:195], s[16:17], v[50:51]
    v_pk_mul_f32 v[188:189], v[188:189], v[208:209]
    v_pk_mul_f32 v[190:191], v[190:191], v[210:211]
    v_pk_mul_f32 v[192:193], v[192:193], v[212:213]
    v_pk_mul_f32 v[194:195], v[194:195], v[214:215]
    s_add_u32 m0, s59, 0
    s_nop 0
    buffer_load_dwordx4 v252, s[36:39], s8 offen offset:0 lds
    v_exp_f32 v188, v188
    v_exp_f32 v189, v189
    v_exp_f32 v190, v190
    v_exp_f32 v191, v191
    buffer_load_dwordx4 v253, s[36:39], s8 offen offset:1024 lds
    v_exp_f32 v192, v192
    v_exp_f32 v193, v193
    v_exp_f32 v194, v194
    v_exp_f32 v195, v195
    v_pk_add_f32 v[188:189], v[188:189], 1.0 op_sel_hi:[1,0]
    v_pk_add_f32 v[190:191], v[190:191], 1.0 op_sel_hi:[1,0]
    v_pk_add_f32 v[192:193], v[192:193], 1.0 op_sel_hi:[1,0]
    v_pk_add_f32 v[194:195], v[194:195], 1.0 op_sel_hi:[1,0]
    buffer_load_dwordx4 v254, s[36:39], s8 offen offset:2048 lds
    v_rcp_f32 v188, v188
    v_rcp_f32 v189, v189
    v_rcp_f32 v190, v190
    v_rcp_f32 v191, v191
    buffer_load_dwordx4 v255, s[36:39], s8 offen offset:3072 lds
    v_rcp_f32 v192, v192
    v_rcp_f32 v193, v193
    v_rcp_f32 v194, v194
    v_rcp_f32 v195, v195
    v_pk_mul_f32 v[188:189], v[188:189], v[208:209]
    v_pk_mul_f32 v[190:191], v[190:191], v[210:211]
    v_pk_mul_f32 v[192:193], v[192:193], v[212:213]
    v_pk_mul_f32 v[194:195], v[194:195], v[214:215]
    v_cvt_pk_bf16_f32 v136, v188, v189
    v_cvt_pk_bf16_f32 v137, v190, v191
    v_cvt_pk_bf16_f32 v138, v192, v193
    v_cvt_pk_bf16_f32 v139, v194, v195
    buffer_store_dwordx4 v[136:139], v245, s[32:35], 0 offen sc1
    s_waitcnt vmcnt(9)
    ds_write_b128 v45, v[224:227] offset:0
    s_waitcnt vmcnt(8)
    ds_write_b128 v45, v[228:231] offset:256
    s_waitcnt vmcnt(7)
    ds_write_b128 v45, v[232:235] offset:512
    s_waitcnt vmcnt(6)
    ds_write_b128 v45, v[236:239] offset:768
    v_pk_mul_f32 v[196:197], v[216:217], v[216:217]
    v_pk_mul_f32 v[198:199], v[218:219], v[218:219]
    v_pk_mul_f32 v[200:201], v[220:221], v[220:221]
    v_pk_mul_f32 v[202:203], v[222:223], v[222:223]
    v_pk_fma_f32 v[196:197], v[196:197], s[16:17], v[50:51]
    v_pk_fma_f32 v[198:199], v[198:199], s[16:17], v[50:51]
    v_pk_fma_f32 v[200:201], v[200:201], s[16:17], v[50:51]
    v_pk_fma_f32 v[202:203], v[202:203], s[16:17], v[50:51]
    v_pk_mul_f32 v[196:197], v[196:197], v[216:217]
    v_pk_mul_f32 v[198:199], v[198:199], v[218:219]
    v_pk_mul_f32 v[200:201], v[200:201], v[220:221]
    v_pk_mul_f32 v[202:203], v[202:203], v[222:223]
    v_exp_f32 v196, v196
    v_exp_f32 v197, v197
    v_exp_f32 v198, v198
    v_exp_f32 v199, v199
    v_exp_f32 v200, v200
    v_exp_f32 v201, v201
    v_exp_f32 v202, v202
    v_exp_f32 v203, v203
    v_pk_add_f32 v[196:197], v[196:197], 1.0 op_sel_hi:[1,0]
    v_pk_add_f32 v[198:199], v[198:199], 1.0 op_sel_hi:[1,0]
    v_pk_add_f32 v[200:201], v[200:201], 1.0 op_sel_hi:[1,0]
    v_pk_add_f32 v[202:203], v[202:203], 1.0 op_sel_hi:[1,0]
    v_rcp_f32 v196, v196
    v_rcp_f32 v197, v197
    v_rcp_f32 v198, v198
    v_rcp_f32 v199, v199
    v_rcp_f32 v200, v200
    v_rcp_f32 v201, v201
    v_rcp_f32 v202, v202
    v_rcp_f32 v203, v203
    v_pk_mul_f32 v[196:197], v[196:197], v[216:217]
    v_pk_mul_f32 v[198:199], v[198:199], v[218:219]
    v_pk_mul_f32 v[200:201], v[200:201], v[220:221]
    v_pk_mul_f32 v[202:203], v[202:203], v[222:223]
    v_cvt_pk_bf16_f32 v140, v196, v197
    v_cvt_pk_bf16_f32 v141, v198, v199
    v_cvt_pk_bf16_f32 v142, v200, v201
    v_cvt_pk_bf16_f32 v143, v202, v203
    buffer_store_dwordx4 v[140:143], v245, s[32:35], s7 offen sc1
    ds_read_b64 v[96:97], v52 offset:14336
    ds_read_b64 v[98:99], v52 offset:14368
    ds_read_b64 v[100:101], v52 offset:12288
    ds_read_b64 v[102:103], v52 offset:12320
    ds_read_b64 v[104:105], v52 offset:10240
    ds_read_b64 v[106:107], v52 offset:10272
    ds_read_b64 v[108:109], v52 offset:8192
    ds_read_b64 v[110:111], v52 offset:8224
    s_waitcnt lgkmcnt(8)
    s_barrier
    ds_read_b128 v[112:115], v53 offset:64
    ds_read_b128 v[116:119], v53 offset:576
    ds_read_b128 v[120:123], v53 offset:1088
    ds_read_b128 v[124:127], v53 offset:1600
    s_waitcnt lgkmcnt(3)
    v_mfma_f32_16x16x32_bf16 a[92:95], v[96:99], v[112:115], 0
    ds_read_b64 v[128:129], v52 offset:6144
    s_add_u32 m0, s59, 4096
    v_mfma_f32_16x16x32_bf16 a[88:91], v[100:103], v[112:115], 0
    s_waitcnt lgkmcnt(3)
    ds_read_b64 v[130:131], v52 offset:6176
    buffer_load_dwordx4 v252, s[36:39], s9 offen offset:0 lds
    v_mfma_f32_16x16x32_bf16 a[92:95], v[100:103], v[116:119], a[92:95]
    ds_read_b128 v[132:135], v53 offset:2112
    v_mfma_f32_16x16x32_bf16 a[84:87], v[104:107], v[112:115], 0
    ds_read_b64 v[136:137], v52 offset:4096
    v_mfma_f32_16x16x32_bf16 a[88:91], v[104:107], v[116:119], a[88:91]
    s_waitcnt lgkmcnt(5)
    ds_read_b64 v[138:139], v52 offset:4128
    buffer_load_dwordx4 v253, s[36:39], s9 offen offset:1024 lds
    v_mfma_f32_16x16x32_bf16 a[92:95], v[104:107], v[120:123], a[92:95]
    ds_read_b128 v[140:143], v53 offset:2624
    v_mfma_f32_16x16x32_bf16 a[80:83], v[108:111], v[112:115], 0
    ds_read_b64 v[144:145], v52 offset:2048
    v_mfma_f32_16x16x32_bf16 a[84:87], v[108:111], v[116:119], a[84:87]
    ds_read_b64 v[146:147], v52 offset:2080
    buffer_load_dwordx4 v254, s[36:39], s9 offen offset:2048 lds
    v_mfma_f32_16x16x32_bf16 a[88:91], v[108:111], v[120:123], a[88:91]
    s_waitcnt lgkmcnt(5)
    ds_read_b128 v[148:151], v53 offset:3136
    v_mfma_f32_16x16x32_bf16 a[92:95], v[108:111], v[124:127], a[92:95]
    ds_read_b64 v[152:153], v52 offset:0
    v_mfma_f32_16x16x32_bf16 a[76:79], v[128:131], v[112:115], 0
    ds_read_b64 v[154:155], v52 offset:32
    buffer_load_dwordx4 v255, s[36:39], s9 offen offset:3072 lds
    v_mfma_f32_16x16x32_bf16 a[80:83], v[128:131], v[116:119], a[80:83]
    ds_read_b128 v[156:159], v53 offset:3648
    s_add_u32 m0, s59, 8192
    v_mfma_f32_16x16x32_bf16 a[84:87], v[128:131], v[120:123], a[84:87]
    ds_read_b64 v[160:161], v52 offset:256
    v_mfma_f32_16x16x32_bf16 a[88:91], v[128:131], v[124:127], a[88:91]
    ds_read_b64 v[162:163], v52 offset:288
    buffer_load_dwordx4 v252, s[36:39], s10 offen offset:0 lds
    v_mfma_f32_16x16x32_bf16 a[92:95], v[128:131], v[132:135], a[92:95]
    s_waitcnt lgkmcnt(5)
    ds_read_b128 v[164:167], v53 offset:0
    v_mfma_f32_16x16x32_bf16 a[72:75], v[136:139], v[112:115], 0
    ds_read_b128 v[168:171], v53 offset:512
    v_mfma_f32_16x16x32_bf16 a[76:79], v[136:139], v[116:119], a[76:79]
    ds_read_b128 v[172:175], v53 offset:1024
    v_mfma_f32_16x16x32_bf16 a[80:83], v[136:139], v[120:123], a[80:83]
    ds_read_b128 v[96:99], v53 offset:1536
    v_mfma_f32_16x16x32_bf16 a[84:87], v[136:139], v[124:127], a[84:87]
    ds_read_b128 v[100:103], v53 offset:2048
    v_mfma_f32_16x16x32_bf16 a[88:91], v[136:139], v[132:135], a[88:91]
    ds_read_b128 v[104:107], v53 offset:2560
    v_mfma_f32_16x16x32_bf16 a[92:95], v[136:139], v[140:143], a[92:95]
    ds_read_b128 v[108:111], v53 offset:3072
    v_mfma_f32_16x16x32_bf16 a[68:71], v[144:147], v[112:115], 0
    ds_read_b128 v[128:131], v53 offset:3584
    v_mfma_f32_16x16x32_bf16 a[72:75], v[144:147], v[116:119], a[72:75]
    ds_read_b64 v[136:137], v52 offset:2304
    v_mfma_f32_16x16x32_bf16 a[76:79], v[144:147], v[120:123], a[76:79]
    ds_read_b64 v[138:139], v52 offset:2336
    v_mfma_f32_16x16x32_bf16 a[80:83], v[144:147], v[124:127], a[80:83]
    v_mfma_f32_16x16x32_bf16 a[84:87], v[144:147], v[132:135], a[84:87]
    v_mfma_f32_16x16x32_bf16 a[88:91], v[144:147], v[140:143], a[88:91]
    v_mfma_f32_16x16x32_bf16 a[92:95], v[144:147], v[148:151], a[92:95]
    s_waitcnt lgkmcnt(2)
    ds_read_b64 v[144:145], v52 offset:4352
    v_mfma_f32_16x16x32_bf16 a[64:67], v[152:155], v[112:115], 0
    ds_read_b64 v[146:147], v52 offset:4384
    v_mfma_f32_16x16x32_bf16 a[68:71], v[152:155], v[116:119], a[68:71]
    ds_read_b64 v[112:113], v52 offset:6400
    v_mfma_f32_16x16x32_bf16 a[72:75], v[152:155], v[120:123], a[72:75]
    ds_read_b64 v[114:115], v52 offset:6432
    v_mfma_f32_16x16x32_bf16 a[76:79], v[152:155], v[124:127], a[76:79]
    ds_read_b64 v[116:117], v52 offset:8448
    v_mfma_f32_16x16x32_bf16 a[80:83], v[152:155], v[132:135], a[80:83]
    ds_read_b64 v[118:119], v52 offset:8480
    v_mfma_f32_16x16x32_bf16 a[84:87], v[152:155], v[140:143], a[84:87]
    ds_read_b64 v[120:121], v52 offset:10496
    v_mfma_f32_16x16x32_bf16 a[88:91], v[152:155], v[148:151], a[88:91]
    ds_read_b64 v[122:123], v52 offset:10528
    v_mfma_f32_16x16x32_bf16 a[92:95], v[152:155], v[156:159], a[92:95]
    ds_read_b64 v[124:125], v52 offset:12544
    v_mfma_f32_16x16x32_bf16 a[64:67], v[160:163], v[164:167], a[64:67]
    ds_read_b64 v[126:127], v52 offset:12576
    v_mfma_f32_16x16x32_bf16 a[68:71], v[160:163], v[168:171], a[68:71]
    ds_read_b64 v[132:133], v52 offset:14592
    v_mfma_f32_16x16x32_bf16 a[72:75], v[160:163], v[172:175], a[72:75]
    ds_read_b64 v[134:135], v52 offset:14624
    v_mfma_f32_16x16x32_bf16 a[76:79], v[160:163], v[96:99], a[76:79]
    s_waitcnt vmcnt(5)
    ds_read_b64 v[140:141], v54 offset:14336
    s_barrier
    s_cmp_eq_u32 s50, 0
    s_cbranch_scc0 L_nouflag
    s_mov_b64 exec, 3
    buffer_store_dwordx2 v[4:5], v47, s[32:35], s6 offen sc1
    s_mov_b64 exec, -1
L_nouflag:
    v_mfma_f32_16x16x32_bf16 a[80:83], v[160:163], v[100:103], a[80:83]
    ds_read_b64 v[142:143], v54 offset:14368
    v_mfma_f32_16x16x32_bf16 a[84:87], v[160:163], v[104:107], a[84:87]
    ds_read_b128 v[148:151], v55 offset:192
    v_mfma_f32_16x16x32_bf16 a[88:91], v[160:163], v[108:111], a[88:91]
    ds_read_b64 v[152:153], v54 offset:12288
    v_mfma_f32_16x16x32_bf16 a[92:95], v[160:163], v[128:131], a[92:95]
    s_waitcnt lgkmcnt(6)
    ds_read_b64 v[154:155], v54 offset:12320
    v_mfma_f32_16x16x32_bf16 a[68:71], v[136:139], v[164:167], a[68:71]
    ds_read_b128 v[156:159], v55 offset:704
    v_mfma_f32_16x16x32_bf16 a[72:75], v[136:139], v[168:171], a[72:75]
    ds_read_b64 v[160:161], v54 offset:10240
    v_mfma_f32_16x16x32_bf16 a[76:79], v[136:139], v[172:175], a[76:79]
    ds_read_b64 v[162:163], v54 offset:10272
    v_mfma_f32_16x16x32_bf16 a[80:83], v[136:139], v[96:99], a[80:83]
    ds_read_b128 v[128:131], v55 offset:1216
    v_mfma_f32_16x16x32_bf16 a[84:87], v[136:139], v[100:103], a[84:87]
    v_mfma_f32_16x16x32_bf16 a[88:91], v[136:139], v[104:107], a[88:91]
    v_mfma_f32_16x16x32_bf16 a[92:95], v[136:139], v[108:111], a[92:95]
    ds_read_b64 v[136:137], v54 offset:8192
    v_mfma_f32_16x16x32_bf16 a[72:75], v[144:147], v[164:167], a[72:75]
    ds_read_b64 v[138:139], v54 offset:8224
    v_mfma_f32_16x16x32_bf16 a[76:79], v[144:147], v[168:171], a[76:79]
    ds_read_b128 v[108:111], v55 offset:1728
    v_mfma_f32_16x16x32_bf16 a[80:83], v[144:147], v[172:175], a[80:83]
    v_mfma_f32_16x16x32_bf16 a[84:87], v[144:147], v[96:99], a[84:87]
    buffer_load_dwordx4 v253, s[36:39], s10 offen offset:1024 lds
    v_mfma_f32_16x16x32_bf16 a[88:91], v[144:147], v[100:103], a[88:91]
    v_mfma_f32_16x16x32_bf16 a[92:95], v[144:147], v[104:107], a[92:95]
    ds_read_b64 v[144:145], v54 offset:6144
    v_mfma_f32_16x16x32_bf16 a[76:79], v[112:115], v[164:167], a[76:79]
    ds_read_b64 v[146:147], v54 offset:6176
    buffer_load_dwordx4 v254, s[36:39], s10 offen offset:2048 lds
    v_mfma_f32_16x16x32_bf16 a[80:83], v[112:115], v[168:171], a[80:83]
    ds_read_b128 v[104:107], v55 offset:2240
    v_mfma_f32_16x16x32_bf16 a[84:87], v[112:115], v[172:175], a[84:87]
    v_mfma_f32_16x16x32_bf16 a[88:91], v[112:115], v[96:99], a[88:91]
    buffer_load_dwordx4 v255, s[36:39], s10 offen offset:3072 lds
    s_add_u32 m0, s59, 12288
    v_mfma_f32_16x16x32_bf16 a[92:95], v[112:115], v[100:103], a[92:95]
    ds_read_b64 v[112:113], v54 offset:4096
    v_mfma_f32_16x16x32_bf16 a[80:83], v[116:119], v[164:167], a[80:83]
    ds_read_b64 v[114:115], v54 offset:4128
    v_mfma_f32_16x16x32_bf16 a[84:87], v[116:119], v[168:171], a[84:87]
    ds_read_b128 v[100:103], v55 offset:2752
    buffer_load_dwordx4 v252, s[36:39], s11 offen offset:0 lds
    v_mfma_f32_16x16x32_bf16 a[88:91], v[116:119], v[172:175], a[88:91]
    v_mfma_f32_16x16x32_bf16 a[92:95], v[116:119], v[96:99], a[92:95]
    ds_read_b64 v[116:117], v54 offset:2048
    v_mfma_f32_16x16x32_bf16 a[84:87], v[120:123], v[164:167], a[84:87]
    ds_read_b64 v[118:119], v54 offset:2080
    buffer_load_dwordx4 v253, s[36:39], s11 offen offset:1024 lds
    v_mfma_f32_16x16x32_bf16 a[88:91], v[120:123], v[168:171], a[88:91]
    ds_read_b128 v[96:99], v55 offset:3264
    v_mfma_f32_16x16x32_bf16 a[92:95], v[120:123], v[172:175], a[92:95]
    ds_read_b64 v[120:121], v54 offset:0
    v_mfma_f32_16x16x32_bf16 a[88:91], v[124:127], v[164:167], a[88:91]
    ds_read_b64 v[122:123], v54 offset:32
    buffer_load_dwordx4 v254, s[36:39], s11 offen offset:2048 lds
    v_mfma_f32_16x16x32_bf16 a[92:95], v[124:127], v[168:171], a[92:95]
    s_waitcnt lgkmcnt(5)
    ds_read_b128 v[172:175], v55 offset:3776
    v_mfma_f32_16x16x32_bf16 a[92:95], v[132:135], v[164:167], a[92:95]
    ds_read_b64 v[124:125], v54 offset:256
    v_mfma_f32_16x16x32_bf16 v[92:95], v[140:143], v[148:151], 0
    ds_read_b64 v[126:127], v54 offset:288
    buffer_load_dwordx4 v255, s[36:39], s11 offen offset:3072 lds
    v_mfma_f32_16x16x32_bf16 v[88:91], v[152:155], v[148:151], 0
    ds_read_b128 v[168:171], v55 offset:128
    s_barrier
    v_mfma_f32_16x16x32_bf16 v[92:95], v[152:155], v[156:159], v[92:95]
    ds_read_b128 v[132:135], v55 offset:640
    s_add_u32 m0, s59, 16384
    v_mfma_f32_16x16x32_bf16 v[84:87], v[160:163], v[148:151], 0
    ds_read_b128 v[164:167], v55 offset:1152
    buffer_load_dwordx4 v252, s[36:39], s14 offen offset:0 lds
    v_mfma_f32_16x16x32_bf16 v[88:91], v[160:163], v[156:159], v[88:91]
    ds_read_b128 v[140:143], v55 offset:1664
    v_mfma_f32_16x16x32_bf16 v[92:95], v[160:163], v[128:131], v[92:95]
    ds_read_b128 v[152:155], v55 offset:2176
    s_barrier
    v_mfma_f32_16x16x32_bf16 v[80:83], v[136:139], v[148:151], 0
    ds_read_b128 v[160:163], v55 offset:2688
    buffer_load_dwordx4 v253, s[36:39], s14 offen offset:1024 lds
    v_mfma_f32_16x16x32_bf16 v[84:87], v[136:139], v[156:159], v[84:87]
    ds_read_b64_tr_b16 a[128:129], v248 offset:0
    ds_read_b64_tr_b16 a[130:131], v248 offset:2048
    v_mfma_f32_16x16x32_bf16 v[88:91], v[136:139], v[128:131], v[88:91]
    ds_read_b64_tr_b16 a[132:133], v249 offset:0
    ds_read_b64_tr_b16 a[134:135], v249 offset:2048
    v_mfma_f32_16x16x32_bf16 v[92:95], v[136:139], v[108:111], v[92:95]
    ds_read_b64_tr_b16 a[136:137], v250 offset:0
    buffer_load_dwordx4 v254, s[36:39], s14 offen offset:2048 lds
    v_mfma_f32_16x16x32_bf16 v[76:79], v[144:147], v[148:151], 0
    ds_read_b64_tr_b16 a[138:139], v250 offset:2048
    ds_read_b64_tr_b16 a[140:141], v251 offset:0
    v_mfma_f32_16x16x32_bf16 v[80:83], v[144:147], v[156:159], v[80:83]
    ds_read_b64_tr_b16 a[142:143], v251 offset:2048
    v_mfma_f32_16x16x32_bf16 v[84:87], v[144:147], v[128:131], v[84:87]
    ds_read_b128 v[136:139], v55 offset:3200
    buffer_load_dwordx4 v255, s[36:39], s14 offen offset:3072 lds
    v_mfma_f32_16x16x32_bf16 v[88:91], v[144:147], v[108:111], v[88:91]
    s_waitcnt vmcnt(12)
    ds_read_b64_tr_b16 a[144:145], v248 offset:4096
    s_add_u32 m0, s59, 20480
    v_mfma_f32_16x16x32_bf16 v[92:95], v[144:147], v[104:107], v[92:95]
    ds_read_b64_tr_b16 a[146:147], v248 offset:6144
    ds_read_b64_tr_b16 a[148:149], v249 offset:4096
    v_mfma_f32_16x16x32_bf16 v[72:75], v[112:115], v[148:151], 0
    ds_read_b64_tr_b16 a[150:151], v249 offset:6144
    buffer_load_dwordx4 v252, s[36:39], s15 offen offset:0 lds
    v_mfma_f32_16x16x32_bf16 v[76:79], v[112:115], v[156:159], v[76:79]
    ds_read_b64_tr_b16 a[152:153], v250 offset:4096
    ds_read_b64_tr_b16 a[154:155], v250 offset:6144
    v_mfma_f32_16x16x32_bf16 v[80:83], v[112:115], v[128:131], v[80:83]
    ds_read_b64_tr_b16 a[156:157], v251 offset:4096
    ds_read_b64_tr_b16 a[158:159], v251 offset:6144
    v_mfma_f32_16x16x32_bf16 v[84:87], v[112:115], v[108:111], v[84:87]
    ds_read_b128 v[144:147], v55 offset:3712
    buffer_load_dwordx4 v253, s[36:39], s15 offen offset:1024 lds
    v_mfma_f32_16x16x32_bf16 v[88:91], v[112:115], v[104:107], v[88:91]
    v_mfma_f32_16x16x32_bf16 v[92:95], v[112:115], v[100:103], v[92:95]
    s_waitcnt lgkmcnt(9)
    ds_read_b64 v[112:113], v54 offset:2304
    v_mfma_f32_16x16x32_bf16 v[68:71], v[116:119], v[148:151], 0
    ds_read_b64 v[114:115], v54 offset:2336
    buffer_load_dwordx4 v254, s[36:39], s15 offen offset:2048 lds
    v_mfma_f32_16x16x32_bf16 v[72:75], v[116:119], v[156:159], v[72:75]
    v_mfma_f32_16x16x32_bf16 v[76:79], v[116:119], v[128:131], v[76:79]
    v_mfma_f32_16x16x32_bf16 v[80:83], v[116:119], v[108:111], v[80:83]
    buffer_load_dwordx4 v255, s[36:39], s15 offen offset:3072 lds
    v_mfma_f32_16x16x32_bf16 v[84:87], v[116:119], v[104:107], v[84:87]
    s_waitcnt vmcnt(12)
    ds_read_b64_tr_b16 a[160:161], v248 offset:8192
    s_add_u32 m0, s59, 0
    v_mfma_f32_16x16x32_bf16 v[88:91], v[116:119], v[100:103], v[88:91]
    ds_read_b64_tr_b16 a[162:163], v248 offset:10240
    ds_read_b64_tr_b16 a[164:165], v249 offset:8192
    v_mfma_f32_16x16x32_bf16 v[92:95], v[116:119], v[96:99], v[92:95]
    ds_read_b64_tr_b16 a[166:167], v249 offset:10240
    buffer_load_dwordx4 v252, s[36:39], s18 offen offset:0 lds
    v_mfma_f32_16x16x32_bf16 v[64:67], v[120:123], v[148:151], 0
    ds_read_b64_tr_b16 a[168:169], v250 offset:8192
    ds_read_b64_tr_b16 a[170:171], v250 offset:10240
    v_mfma_f32_16x16x32_bf16 v[68:71], v[120:123], v[156:159], v[68:71]
    ds_read_b64_tr_b16 a[172:173], v251 offset:8192
    ds_read_b64_tr_b16 a[174:175], v251 offset:10240
    v_mfma_f32_16x16x32_bf16 v[72:75], v[120:123], v[128:131], v[72:75]
    ds_read_b64 v[116:117], v54 offset:4352
    buffer_load_dwordx4 v253, s[36:39], s18 offen offset:1024 lds
    v_mfma_f32_16x16x32_bf16 v[76:79], v[120:123], v[108:111], v[76:79]
    ds_read_b64 v[118:119], v54 offset:4384
    v_mfma_f32_16x16x32_bf16 v[80:83], v[120:123], v[104:107], v[80:83]
    ds_read_b64 v[148:149], v54 offset:6400
    v_mfma_f32_16x16x32_bf16 v[84:87], v[120:123], v[100:103], v[84:87]
    ds_read_b64 v[150:151], v54 offset:6432
    buffer_load_dwordx4 v254, s[36:39], s18 offen offset:2048 lds
    v_mfma_f32_16x16x32_bf16 v[88:91], v[120:123], v[96:99], v[88:91]
    ds_read_b64 v[156:157], v54 offset:8448
    v_mfma_f32_16x16x32_bf16 v[92:95], v[120:123], v[172:175], v[92:95]
    ds_read_b64 v[158:159], v54 offset:8480
    v_mfma_f32_16x16x32_bf16 v[64:67], v[124:127], v[168:171], v[64:67]
    ds_read_b64 v[128:129], v54 offset:10496
    buffer_load_dwordx4 v255, s[36:39], s18 offen offset:3072 lds
    v_mfma_f32_16x16x32_bf16 v[68:71], v[124:127], v[132:135], v[68:71]
    s_waitcnt lgkmcnt(14)
    s_waitcnt vmcnt(12)
    ds_read_b64_tr_b16 a[176:177], v248 offset:12288
    s_add_u32 m0, s59, 4096
    v_mfma_f32_16x16x32_bf16 v[72:75], v[124:127], v[164:167], v[72:75]
    ds_read_b64_tr_b16 a[178:179], v248 offset:14336
    ds_read_b64_tr_b16 a[180:181], v249 offset:12288
    v_mfma_f32_16x16x32_bf16 v[76:79], v[124:127], v[140:143], v[76:79]
    ds_read_b64_tr_b16 a[182:183], v249 offset:14336
    buffer_load_dwordx4 v252, s[36:39], s19 offen offset:0 lds
    v_mfma_f32_16x16x32_bf16 v[80:83], v[124:127], v[152:155], v[80:83]
    ds_read_b64_tr_b16 a[184:185], v250 offset:12288
    ds_read_b64_tr_b16 a[186:187], v250 offset:14336
    v_mfma_f32_16x16x32_bf16 v[84:87], v[124:127], v[160:163], v[84:87]
    ds_read_b64_tr_b16 a[188:189], v251 offset:12288
    ds_read_b64_tr_b16 a[190:191], v251 offset:14336
    v_mfma_f32_16x16x32_bf16 v[88:91], v[124:127], v[136:139], v[88:91]
    ds_read_b64 v[130:131], v54 offset:10528
    buffer_load_dwordx4 v253, s[36:39], s19 offen offset:1024 lds
    v_mfma_f32_16x16x32_bf16 v[92:95], v[124:127], v[144:147], v[92:95]
    ds_read_b64 v[108:109], v54 offset:12544
    v_mfma_f32_16x16x32_bf16 v[68:71], v[112:115], v[168:171], v[68:71]
    ds_read_b64 v[110:111], v54 offset:12576
    v_mfma_f32_16x16x32_bf16 v[72:75], v[112:115], v[132:135], v[72:75]
    ds_read_b64 v[104:105], v54 offset:14592
    buffer_load_dwordx4 v254, s[36:39], s19 offen offset:2048 lds
    v_mfma_f32_16x16x32_bf16 v[76:79], v[112:115], v[164:167], v[76:79]
    ds_read_b64 v[106:107], v54 offset:14624
    v_mfma_f32_16x16x32_bf16 v[80:83], v[112:115], v[140:143], v[80:83]
    ds_read_b64 v[100:101], v54 offset:14848
    v_mfma_f32_16x16x32_bf16 v[84:87], v[112:115], v[152:155], v[84:87]
    ds_read_b64 v[102:103], v54 offset:14880
    buffer_load_dwordx4 v255, s[36:39], s19 offen offset:3072 lds
    v_mfma_f32_16x16x32_bf16 v[88:91], v[112:115], v[160:163], v[88:91]
    s_waitcnt lgkmcnt(14)
    s_waitcnt vmcnt(12)
    ds_read_b64_tr_b16 a[192:193], v248 offset:16384
    s_add_u32 m0, s59, 8192
    v_mfma_f32_16x16x32_bf16 v[92:95], v[112:115], v[136:139], v[92:95]
    ds_read_b64_tr_b16 a[194:195], v248 offset:18432
    ds_read_b64_tr_b16 a[196:197], v249 offset:16384
    v_mfma_f32_16x16x32_bf16 v[72:75], v[116:119], v[168:171], v[72:75]
    ds_read_b64_tr_b16 a[198:199], v249 offset:18432
    buffer_load_dwordx4 v252, s[36:39], s20 offen offset:0 lds
    v_mfma_f32_16x16x32_bf16 v[76:79], v[116:119], v[132:135], v[76:79]
    ds_read_b64_tr_b16 a[200:201], v250 offset:16384
    ds_read_b64_tr_b16 a[202:203], v250 offset:18432
    v_mfma_f32_16x16x32_bf16 v[80:83], v[116:119], v[164:167], v[80:83]
    ds_read_b64_tr_b16 a[204:205], v251 offset:16384
    ds_read_b64_tr_b16 a[206:207], v251 offset:18432
    v_mfma_f32_16x16x32_bf16 v[84:87], v[116:119], v[140:143], v[84:87]
    ds_read_b128 v[96:99], v55 offset:64
    buffer_load_dwordx4 v253, s[36:39], s20 offen offset:1024 lds
    v_mfma_f32_16x16x32_bf16 v[88:91], v[116:119], v[152:155], v[88:91]
    ds_read_b64 v[120:121], v54 offset:12800
    v_mfma_f32_16x16x32_bf16 v[92:95], v[116:119], v[160:163], v[92:95]
    ds_read_b64 v[122:123], v54 offset:12832
    v_mfma_f32_16x16x32_bf16 v[76:79], v[148:151], v[168:171], v[76:79]
    ds_read_b128 v[172:175], v55 offset:576
    buffer_load_dwordx4 v254, s[36:39], s20 offen offset:2048 lds
    v_mfma_f32_16x16x32_bf16 v[80:83], v[148:151], v[132:135], v[80:83]
    ds_read_b64 v[124:125], v54 offset:10752
    v_mfma_f32_16x16x32_bf16 v[84:87], v[148:151], v[164:167], v[84:87]
    ds_read_b64 v[126:127], v54 offset:10784
    v_mfma_f32_16x16x32_bf16 v[88:91], v[148:151], v[140:143], v[88:91]
    ds_read_b128 v[144:147], v55 offset:1088
    buffer_load_dwordx4 v255, s[36:39], s20 offen offset:3072 lds
    v_mfma_f32_16x16x32_bf16 v[92:95], v[148:151], v[152:155], v[92:95]
    s_waitcnt lgkmcnt(14)
    s_waitcnt vmcnt(12)
    ds_read_b64_tr_b16 a[208:209], v248 offset:20480
    s_add_u32 m0, s59, 12288
    v_mfma_f32_16x16x32_bf16 v[80:83], v[156:159], v[168:171], v[80:83]
    ds_read_b64_tr_b16 a[210:211], v248 offset:22528
    ds_read_b64_tr_b16 a[212:213], v249 offset:20480
    v_mfma_f32_16x16x32_bf16 v[84:87], v[156:159], v[132:135], v[84:87]
    ds_read_b64_tr_b16 a[214:215], v249 offset:22528
    buffer_load_dwordx4 v252, s[36:39], s21 offen offset:0 lds
    v_mfma_f32_16x16x32_bf16 v[88:91], v[156:159], v[164:167], v[88:91]
    ds_read_b64_tr_b16 a[216:217], v250 offset:20480
    ds_read_b64_tr_b16 a[218:219], v250 offset:22528
    v_mfma_f32_16x16x32_bf16 v[92:95], v[156:159], v[140:143], v[92:95]
    ds_read_b64_tr_b16 a[220:221], v251 offset:20480
    ds_read_b64_tr_b16 a[222:223], v251 offset:22528
    v_mfma_f32_16x16x32_bf16 v[84:87], v[128:131], v[168:171], v[84:87]
    ds_read_b64 v[112:113], v54 offset:8704
    buffer_load_dwordx4 v253, s[36:39], s21 offen offset:1024 lds
    v_mfma_f32_16x16x32_bf16 v[88:91], v[128:131], v[132:135], v[88:91]
    ds_read_b64 v[114:115], v54 offset:8736
    v_mfma_f32_16x16x32_bf16 v[92:95], v[128:131], v[164:167], v[92:95]
    ds_read_b128 v[136:139], v55 offset:1600
    v_mfma_f32_16x16x32_bf16 v[88:91], v[108:111], v[168:171], v[88:91]
    ds_read_b64 v[116:117], v54 offset:6656
    buffer_load_dwordx2 v[36:37], v39, s[32:35], 0 offen sc1
    v_mfma_f32_16x16x32_bf16 v[92:95], v[108:111], v[132:135], v[92:95]
    ds_read_b64 v[118:119], v54 offset:6688
    v_mfma_f32_16x16x32_bf16 v[92:95], v[104:107], v[168:171], v[92:95]
    s_waitcnt lgkmcnt(13)
    ds_read_b128 v[160:163], v55 offset:2112
    v_mfma_f32_16x16x32_bf16 v[92:95], v[100:103], v[96:99], v[92:95]
    ds_read_b64 v[148:149], v54 offset:4608
    buffer_load_dwordx4 v254, s[36:39], s21 offen offset:2048 lds
    v_mfma_f32_16x16x32_bf16 v[88:91], v[120:123], v[96:99], v[88:91]
    ds_read_b64 v[150:151], v54 offset:4640
    v_mfma_f32_16x16x32_bf16 v[92:95], v[120:123], v[172:175], v[92:95]
    ds_read_b128 v[152:155], v55 offset:2624
    v_mfma_f32_16x16x32_bf16 v[84:87], v[124:127], v[96:99], v[84:87]
    ds_read_b64 v[156:157], v54 offset:2560
    buffer_load_dwordx4 v255, s[36:39], s21 offen offset:3072 lds
    v_mfma_f32_16x16x32_bf16 v[88:91], v[124:127], v[172:175], v[88:91]
    s_waitcnt vmcnt(13)
    ds_read_b64_tr_b16 a[224:225], v248 offset:0
    ds_read_b64_tr_b16 a[226:227], v248 offset:2048
    v_mfma_f32_16x16x32_bf16 v[92:95], v[124:127], v[144:147], v[92:95]
    s_waitcnt lgkmcnt(6)
    ds_read_b64_tr_b16 a[228:229], v249 offset:0
    ds_read_b64_tr_b16 a[230:231], v249 offset:2048
    v_mfma_f32_16x16x32_bf16 v[80:83], v[112:115], v[96:99], v[80:83]
    ds_read_b64_tr_b16 a[232:233], v250 offset:0
    ds_read_b64_tr_b16 a[234:235], v250 offset:2048
    v_mfma_f32_16x16x32_bf16 v[84:87], v[112:115], v[172:175], v[84:87]
    ds_read_b64_tr_b16 a[236:237], v251 offset:0
    ds_read_b64_tr_b16 a[238:239], v251 offset:2048
    v_mfma_f32_16x16x32_bf16 v[88:91], v[112:115], v[144:147], v[88:91]
    ds_read_b64 v[158:159], v54 offset:2592
    v_mfma_f32_16x16x32_bf16 v[92:95], v[112:115], v[136:139], v[92:95]
    ds_read_b128 v[140:143], v55 offset:3136
    v_mfma_f32_16x16x32_bf16 v[76:79], v[116:119], v[96:99], v[76:79]
    s_waitcnt lgkmcnt(2)
    ds_read_b64 v[128:129], v54 offset:512
    s_add_u32 m0, s59, 0
    v_mfma_f32_16x16x32_bf16 v[80:83], v[116:119], v[172:175], v[80:83]
    ds_read_b64 v[130:131], v54 offset:544
    buffer_load_dwordx4 v252, s[36:39], s26 offen offset:0 lds
    v_mfma_f32_16x16x32_bf16 v[84:87], v[116:119], v[144:147], v[84:87]
    ds_read_b128 v[164:167], v55 offset:3648
    v_mfma_f32_16x16x32_bf16 v[88:91], v[116:119], v[136:139], v[88:91]
    ds_read_b64 v[108:109], v54 offset:768
    v_mfma_f32_16x16x32_bf16 v[92:95], v[116:119], v[160:163], v[92:95]
    ds_read_b64 v[110:111], v54 offset:800
    buffer_load_dwordx4 v253, s[36:39], s26 offen offset:1024 lds
    v_mfma_f32_16x16x32_bf16 v[72:75], v[148:151], v[96:99], v[72:75]
    ds_read_b128 v[132:135], v55 offset:0
    v_mfma_f32_16x16x32_bf16 v[76:79], v[148:151], v[172:175], v[76:79]
    ds_read_b128 v[104:107], v55 offset:512
    v_mfma_f32_16x16x32_bf16 v[80:83], v[148:151], v[144:147], v[80:83]
    ds_read_b128 v[168:171], v55 offset:1024
    buffer_load_dwordx4 v254, s[36:39], s26 offen offset:2048 lds
    v_mfma_f32_16x16x32_bf16 v[84:87], v[148:151], v[136:139], v[84:87]
    ds_read_b128 v[100:103], v55 offset:1536
    v_mfma_f32_16x16x32_bf16 v[88:91], v[148:151], v[160:163], v[88:91]
    ds_read_b128 v[120:123], v55 offset:2048
    v_mfma_f32_16x16x32_bf16 v[92:95], v[148:151], v[152:155], v[92:95]
    s_waitcnt lgkmcnt(5)
    ds_read_b128 v[124:127], v55 offset:2560
    buffer_load_dwordx4 v255, s[36:39], s26 offen offset:3072 lds
    v_mfma_f32_16x16x32_bf16 v[68:71], v[156:159], v[96:99], v[68:71]
    s_waitcnt vmcnt(13)
    ds_read_b64_tr_b16 a[240:241], v248 offset:4096
    ds_read_b64_tr_b16 a[242:243], v248 offset:6144
    v_mfma_f32_16x16x32_bf16 v[72:75], v[156:159], v[172:175], v[72:75]
    ds_read_b64_tr_b16 a[244:245], v249 offset:4096
    ds_read_b64_tr_b16 a[246:247], v249 offset:6144
    v_mfma_f32_16x16x32_bf16 v[76:79], v[156:159], v[144:147], v[76:79]
    ds_read_b64_tr_b16 a[248:249], v250 offset:4096
    ds_read_b64_tr_b16 a[250:251], v250 offset:6144
    v_mfma_f32_16x16x32_bf16 v[80:83], v[156:159], v[136:139], v[80:83]
    ds_read_b64_tr_b16 a[252:253], v251 offset:4096
    ds_read_b64_tr_b16 a[254:255], v251 offset:6144
    v_mfma_f32_16x16x32_bf16 v[84:87], v[156:159], v[160:163], v[84:87]
    ds_read_b128 v[112:115], v55 offset:3072
    v_mfma_f32_16x16x32_bf16 v[88:91], v[156:159], v[152:155], v[88:91]
    ds_read_b128 v[116:119], v55 offset:3584
    v_mfma_f32_16x16x32_bf16 v[92:95], v[156:159], v[140:143], v[92:95]
    s_waitcnt lgkmcnt(2)
    ds_read_b64 v[148:149], v54 offset:2816
    s_add_u32 m0, s59, 4096
    v_mfma_f32_16x16x32_bf16 v[64:67], v[128:131], v[96:99], v[64:67]
    ds_read_b64 v[150:151], v54 offset:2848
    buffer_load_dwordx4 v252, s[36:39], s27 offen offset:0 lds
    v_mfma_f32_16x16x32_bf16 v[68:71], v[128:131], v[172:175], v[68:71]
    ds_read_b64 v[156:157], v54 offset:4864
    v_mfma_f32_16x16x32_bf16 v[72:75], v[128:131], v[144:147], v[72:75]
    ds_read_b64 v[158:159], v54 offset:4896
    v_mfma_f32_16x16x32_bf16 v[76:79], v[128:131], v[136:139], v[76:79]
    ds_read_b64 v[96:97], v54 offset:6912
    buffer_load_dwordx4 v253, s[36:39], s27 offen offset:1024 lds
    v_mfma_f32_16x16x32_bf16 v[80:83], v[128:131], v[160:163], v[80:83]
    ds_read_b64 v[98:99], v54 offset:6944
    v_mfma_f32_16x16x32_bf16 v[84:87], v[128:131], v[152:155], v[84:87]
    ds_read_b64 v[172:173], v54 offset:8960
    v_mfma_f32_16x16x32_bf16 v[88:91], v[128:131], v[140:143], v[88:91]
    ds_read_b64 v[174:175], v54 offset:8992
    buffer_load_dwordx4 v254, s[36:39], s27 offen offset:2048 lds
    v_mfma_f32_16x16x32_bf16 v[92:95], v[128:131], v[164:167], v[92:95]
    ds_read_b64 v[144:145], v54 offset:11008
    v_mfma_f32_16x16x32_bf16 v[64:67], v[108:111], v[132:135], v[64:67]
    ds_read_b64 v[146:147], v54 offset:11040
    v_mfma_f32_16x16x32_bf16 v[68:71], v[108:111], v[104:107], v[68:71]
    ds_read_b64 v[136:137], v54 offset:13056
    buffer_load_dwordx4 v255, s[36:39], s27 offen offset:3072 lds
    v_mfma_f32_16x16x32_bf16 v[72:75], v[108:111], v[168:171], v[72:75]
    s_waitcnt vmcnt(10)
    v_cmp_ne_u64 vcc, s[48:49], v[36:37]
    s_cbranch_vccz L_pollu_ok
    s_mov_b32 s3, 0
L_pollu:
    s_mov_b64 exec, vcc
    buffer_load_dwordx2 v[36:37], v39, s[32:35], 0 offen sc1
    s_waitcnt vmcnt(0)
    v_cmp_ne_u64 vcc, s[48:49], v[36:37]
    s_add_u32 s3, s3, 1
    s_cbranch_vccz L_pollu_out
    s_cmp_lt_u32 s3, 200000
    s_cbranch_scc1 L_pollu
L_pollu_out:
    s_mov_b64 exec, -1
L_pollu_ok:
    ds_read_b64 v[138:139], v54 offset:13088
    v_mfma_f32_16x16x32_bf16 v[76:79], v[108:111], v[100:103], v[76:79]
    ds_read_b64 v[160:161], v54 offset:15104
    v_mfma_f32_16x16x32_bf16 v[80:83], v[108:111], v[120:123], v[80:83]
    ds_read_b64 v[162:163], v54 offset:15136
    buffer_load_dwordx4 v[176:179], v48, s[32:35], s40 offen offset:0 sc1
    v_mfma_f32_16x16x32_bf16 v[84:87], v[108:111], v[124:127], v[84:87]
    s_waitcnt lgkmcnt(6)
    v_mfma_f32_16x16x32_bf16 v[88:91], v[108:111], v[112:115], v[88:91]
    v_mfma_f32_16x16x32_bf16 v[92:95], v[108:111], v[116:119], v[92:95]
    buffer_load_dwordx4 v[180:183], v48, s[32:35], s41 offen offset:0 sc1
    v_mfma_f32_16x16x32_bf16 v[68:71], v[148:151], v[132:135], v[68:71]
    v_mfma_f32_16x16x32_bf16 v[72:75], v[148:151], v[104:107], v[72:75]
    v_mfma_f32_16x16x32_bf16 v[76:79], v[148:151], v[168:171], v[76:79]
    buffer_load_dwordx4 v[184:187], v48, s[32:35], s42 offen offset:0 sc1
    v_mfma_f32_16x16x32_bf16 v[80:83], v[148:151], v[100:103], v[80:83]
    v_mfma_f32_16x16x32_bf16 v[84:87], v[148:151], v[120:123], v[84:87]
    v_mfma_f32_16x16x32_bf16 v[88:91], v[148:151], v[124:127], v[88:91]
    buffer_load_dwordx4 v[188:191], v48, s[32:35], s43 offen offset:0 sc1
    v_mfma_f32_16x16x32_bf16 v[92:95], v[148:151], v[112:115], v[92:95]
    v_mfma_f32_16x16x32_bf16 v[72:75], v[156:159], v[132:135], v[72:75]
    v_mfma_f32_16x16x32_bf16 v[76:79], v[156:159], v[104:107], v[76:79]
    buffer_load_dwordx4 v[192:195], v48, s[32:35], s44 offen offset:0 sc1
    v_mfma_f32_16x16x32_bf16 v[80:83], v[156:159], v[168:171], v[80:83]
    v_mfma_f32_16x16x32_bf16 v[84:87], v[156:159], v[100:103], v[84:87]
    v_mfma_f32_16x16x32_bf16 v[88:91], v[156:159], v[120:123], v[88:91]
    buffer_load_dwordx4 v[196:199], v48, s[32:35], s45 offen offset:0 sc1
    v_mfma_f32_16x16x32_bf16 v[92:95], v[156:159], v[124:127], v[92:95]
    v_mfma_f32_16x16x32_bf16 v[76:79], v[96:99], v[132:135], v[76:79]
    v_mfma_f32_16x16x32_bf16 v[80:83], v[96:99], v[104:107], v[80:83]
    buffer_load_dwordx4 v[200:203], v48, s[32:35], s46 offen offset:0 sc1
    v_mfma_f32_16x16x32_bf16 v[84:87], v[96:99], v[168:171], v[84:87]
    v_mfma_f32_16x16x32_bf16 v[88:91], v[96:99], v[100:103], v[88:91]
    ds_write_b128 v43, a[64:67] offset:16384
    v_mfma_f32_16x16x32_bf16 v[92:95], v[96:99], v[120:123], v[92:95]
    buffer_load_dwordx4 v[204:207], v48, s[32:35], s47 offen offset:0 sc1
    v_mfma_f32_16x16x32_bf16 v[80:83], v[172:175], v[132:135], v[80:83]
    ds_write_b128 v43, a[68:71] offset:17408
    v_mfma_f32_16x16x32_bf16 v[84:87], v[172:175], v[104:107], v[84:87]
    v_mfma_f32_16x16x32_bf16 v[88:91], v[172:175], v[168:171], v[88:91]
    ds_write_b128 v43, a[72:75] offset:18432
    buffer_load_dwordx4 v[208:211], v48, s[32:35], s0 offen offset:0 sc1
    v_mfma_f32_16x16x32_bf16 v[92:95], v[172:175], v[100:103], v[92:95]
    s_waitcnt lgkmcnt(3)
    v_mfma_f32_16x16x32_bf16 v[84:87], v[144:147], v[132:135], v[84:87]
    ds_write_b128 v43, a[76:79] offset:19456
    v_mfma_f32_16x16x32_bf16 v[88:91], v[144:147], v[104:107], v[88:91]
    buffer_load_dwordx4 v[212:215], v48, s[32:35], s1 offen offset:0 sc1
    v_mfma_f32_16x16x32_bf16 v[92:95], v[144:147], v[168:171], v[92:95]
    ds_write_b128 v43, a[80:83] offset:20480
    v_mfma_f32_16x16x32_bf16 v[88:91], v[136:139], v[132:135], v[88:91]
    v_mfma_f32_16x16x32_bf16 v[92:95], v[136:139], v[104:107], v[92:95]
    ds_write_b128 v43, a[84:87] offset:21504
    buffer_load_dwordx4 v[216:219], v48, s[32:35], s30 offen offset:0 sc1
    v_mfma_f32_16x16x32_bf16 v[92:95], v[160:163], v[132:135], v[92:95]
    ds_write_b128 v43, a[88:91] offset:22528
    ds_write_b128 v43, a[92:95] offset:23552
    s_bitcmp1_b32 s50, 0
    s_cbranch_scc1 L_mw_odd
    ds_write_b128 v14, v[80:83] offset:0
    ds_write_b128 v14, v[84:87] offset:1024
    ds_write_b128 v14, v[88:91] offset:2048
    s_nop 0
    ds_write_b128 v14, v[92:95] offset:3072
    s_branch L_mw_done
L_mw_odd:
    ds_write_b128 v14, v[64:67] offset:0
    v_mov_b64 v[64:65], v[80:81]
    v_mov_b64 v[66:67], v[82:83]
    ds_write_b128 v14, v[68:71] offset:1024
    v_mov_b64 v[68:69], v[84:85]
    v_mov_b64 v[70:71], v[86:87]
    ds_write_b128 v14, v[72:75] offset:2048
    v_mov_b64 v[72:73], v[88:89]
    v_mov_b64 v[74:75], v[90:91]
    ds_write_b128 v14, v[76:79] offset:3072
    v_mov_b64 v[76:77], v[92:93]
    v_mov_b64 v[78:79], v[94:95]
L_mw_done:
    s_waitcnt lgkmcnt(0)
    s_barrier
    ds_read_b128 v[96:99], v15 offset:0
    ds_read_b128 v[100:103], v15 offset:1024
    ds_read_b128 v[104:107], v15 offset:2048
    buffer_load_dwordx4 v[220:223], v48, s[32:35], s31 offen offset:0 sc1
    ds_read_b128 v[108:111], v15 offset:3072
    ds_read_b128 v[120:123], v6 offset:0
    ds_read_b128 v[124:127], v6 offset:1024
    ds_read_b128 v[128:131], v6 offset:24576
    ds_read_b128 v[132:135], v6 offset:25600
    buffer_load_dwordx4 v[224:227], v48, s[32:35], s40 offen offset:1024 sc1
    ds_read_b128 v[136:139], v7 offset:0
    ds_read_b128 v[140:143], v7 offset:1024
    ds_read_b128 v[144:147], v7 offset:24576
    ds_read_b128 v[148:151], v7 offset:25600
    s_waitcnt lgkmcnt(10)
    buffer_load_dwordx4 v[228:231], v48, s[32:35], s41 offen offset:1024 sc1
    v_pk_add_f32 v[96:97], v[96:97], v[64:65]
    v_pk_add_f32 v[98:99], v[98:99], v[66:67]
    v_pk_add_f32 v[100:101], v[100:101], v[68:69]
    v_pk_add_f32 v[102:103], v[102:103], v[70:71]
    v_cvt_pk_bf16_f32 v112, v96, v97
    buffer_load_dwordx4 v[232:235], v48, s[32:35], s42 offen offset:1024 sc1
    v_cvt_pk_bf16_f32 v113, v98, v99
    v_cvt_pk_bf16_f32 v114, v100, v101
    v_cvt_pk_bf16_f32 v115, v102, v103
    s_nop 0
    v_permlane16_swap_b32 v112, v114
    v_permlane16_swap_b32 v113, v115
    buffer_store_dwordx4 v[112:115], v9, s[32:35], 0 offen offset:0 sc1
    s_waitcnt lgkmcnt(8)
    v_pk_add_f32 v[104:105], v[104:105], v[72:73]
    v_pk_add_f32 v[106:107], v[106:107], v[74:75]
    v_pk_add_f32 v[108:109], v[108:109], v[76:77]
    v_pk_add_f32 v[110:111], v[110:111], v[78:79]
    v_cvt_pk_bf16_f32 v116, v104, v105
    v_cvt_pk_bf16_f32 v117, v106, v107
    v_cvt_pk_bf16_f32 v118, v108, v109
    v_cvt_pk_bf16_f32 v119, v110, v111
    s_nop 0
    v_permlane16_swap_b32 v116, v118
    v_permlane16_swap_b32 v117, v119
    buffer_store_dwordx4 v[116:119], v9, s[32:35], 0 offen offset:1024 sc1
    s_waitcnt lgkmcnt(4)
    v_pk_add_f32 v[120:121], v[120:121], v[128:129]
    v_pk_add_f32 v[122:123], v[122:123], v[130:131]
    v_pk_add_f32 v[124:125], v[124:125], v[132:133]
    v_pk_add_f32 v[126:127], v[126:127], v[134:135]
    s_waitcnt lgkmcnt(2)
    v_pk_add_f32 v[120:121], v[120:121], v[136:137]
    v_pk_add_f32 v[122:123], v[122:123], v[138:139]
    v_pk_add_f32 v[124:125], v[124:125], v[140:141]
    v_pk_add_f32 v[126:127], v[126:127], v[142:143]
    s_waitcnt lgkmcnt(0)
    v_pk_add_f32 v[120:121], v[120:121], v[144:145]
    v_pk_add_f32 v[122:123], v[122:123], v[146:147]
    v_pk_add_f32 v[124:125], v[124:125], v[148:149]
    v_pk_add_f32 v[126:127], v[126:127], v[150:151]
    v_cvt_pk_bf16_f32 v28, v120, v121
    v_cvt_pk_bf16_f32 v29, v122, v123
    v_cvt_pk_bf16_f32 v30, v124, v125
    v_cvt_pk_bf16_f32 v31, v126, v127
    s_nop 0
    v_permlane16_swap_b32 v28, v30
    v_permlane16_swap_b32 v29, v31
    buffer_store_dwordx4 v[28:31], v8, s[32:35], 0 offen offset:0 sc1
    v_sub_f32 v58, 1.0, v56
    v_lshlrev_b32 v62, 16, v62
    v_mul_f32 v60, v58, v62
    s_lshl_b32 s16, s51, 4
    s_add_u32 s16, s16, 36864
    s_waitcnt vmcnt(17)
    v_mfma_f32_16x16x32_bf16 v[236:239], v[176:179], a[128:131], 0
    ds_read_b64_tr_b16 a[0:1], v248 offset:8192
    v_mfma_f32_16x16x32_bf16 a[96:99], v[176:179], a[132:135], 0
    ds_read_b64_tr_b16 a[2:3], v248 offset:10240
    v_mfma_f32_16x16x32_bf16 a[100:103], v[176:179], a[136:139], 0
    ds_read_b64_tr_b16 a[4:5], v249 offset:8192
    v_mfma_f32_16x16x32_bf16 a[104:107], v[176:179], a[140:143], 0
    s_waitcnt vmcnt(16)
    ds_read_b64_tr_b16 a[6:7], v249 offset:10240
    v_mfma_f32_16x16x32_bf16 v[236:239], v[180:183], a[144:147], v[236:239]
    buffer_load_dwordx4 v[176:179], v48, s[32:35], s43 offen offset:1024 sc1
    ds_read_b64_tr_b16 a[8:9], v250 offset:8192
    v_mfma_f32_16x16x32_bf16 a[96:99], v[180:183], a[148:151], a[96:99]
    ds_read_b64_tr_b16 a[10:11], v250 offset:10240
    v_mfma_f32_16x16x32_bf16 a[100:103], v[180:183], a[152:155], a[100:103]
    ds_read_b64_tr_b16 a[12:13], v251 offset:8192
    v_mfma_f32_16x16x32_bf16 a[104:107], v[180:183], a[156:159], a[104:107]
    s_waitcnt vmcnt(16)
    ds_read_b64_tr_b16 a[14:15], v251 offset:10240
    v_mfma_f32_16x16x32_bf16 v[236:239], v[184:187], a[160:163], v[236:239]
    buffer_load_dwordx4 v[180:183], v48, s[32:35], s44 offen offset:1024 sc1
    ds_read_b64_tr_b16 a[16:17], v248 offset:12288
    v_mfma_f32_16x16x32_bf16 a[96:99], v[184:187], a[164:167], a[96:99]
    ds_read_b64_tr_b16 a[18:19], v248 offset:14336
    v_mfma_f32_16x16x32_bf16 a[100:103], v[184:187], a[168:171], a[100:103]
    ds_read_b64_tr_b16 a[20:21], v249 offset:12288
    v_mfma_f32_16x16x32_bf16 a[104:107], v[184:187], a[172:175], a[104:107]
    s_waitcnt vmcnt(16)
    ds_read_b64_tr_b16 a[22:23], v249 offset:14336
    v_mfma_f32_16x16x32_bf16 v[236:239], v[188:191], a[176:179], v[236:239]
    buffer_load_dwordx4 v[184:187], v48, s[32:35], s45 offen offset:1024 sc1
    ds_read_b64_tr_b16 a[24:25], v250 offset:12288
    v_mfma_f32_16x16x32_bf16 a[96:99], v[188:191], a[180:183], a[96:99]
    ds_read_b64_tr_b16 a[26:27], v250 offset:14336
    v_mfma_f32_16x16x32_bf16 a[100:103], v[188:191], a[184:187], a[100:103]
    ds_read_b64_tr_b16 a[28:29], v251 offset:12288
    v_mfma_f32_16x16x32_bf16 a[104:107], v[188:191], a[188:191], a[104:107]
    s_waitcnt vmcnt(16)
    ds_read_b64_tr_b16 a[30:31], v251 offset:14336
    v_mfma_f32_16x16x32_bf16 v[236:239], v[192:195], a[192:195], v[236:239]
    buffer_load_dwordx4 v[188:191], v48, s[32:35], s46 offen offset:1024 sc1
    ds_read_b64_tr_b16 a[32:33], v248 offset:0
    v_mfma_f32_16x16x32_bf16 a[96:99], v[192:195], a[196:199], a[96:99]
    ds_read_b64_tr_b16 a[34:35], v248 offset:2048
    v_mfma_f32_16x16x32_bf16 a[100:103], v[192:195], a[200:203], a[100:103]
    ds_read_b64_tr_b16 a[36:37], v249 offset:0
    v_mfma_f32_16x16x32_bf16 a[104:107], v[192:195], a[204:207], a[104:107]
    s_waitcnt vmcnt(16)
    ds_read_b64_tr_b16 a[38:39], v249 offset:2048
    v_mfma_f32_16x16x32_bf16 v[236:239], v[196:199], a[208:211], v[236:239]
    buffer_load_dwordx4 v[192:195], v48, s[32:35], s47 offen offset:1024 sc1
    ds_read_b64_tr_b16 a[40:41], v250 offset:0
    v_mfma_f32_16x16x32_bf16 a[96:99], v[196:199], a[212:215], a[96:99]
    ds_read_b64_tr_b16 a[42:43], v250 offset:2048
    v_mfma_f32_16x16x32_bf16 a[100:103], v[196:199], a[216:219], a[100:103]
    ds_read_b64_tr_b16 a[44:45], v251 offset:0
    v_mfma_f32_16x16x32_bf16 a[104:107], v[196:199], a[220:223], a[104:107]
    s_waitcnt vmcnt(16)
    ds_read_b64_tr_b16 a[46:47], v251 offset:2048
    v_mfma_f32_16x16x32_bf16 v[236:239], v[200:203], a[224:227], v[236:239]
    buffer_load_dwordx4 v[196:199], v48, s[32:35], s0 offen offset:1024 sc1
    ds_read_b64_tr_b16 a[48:49], v248 offset:4096
    v_mfma_f32_16x16x32_bf16 a[96:99], v[200:203], a[228:231], a[96:99]
    ds_read_b64_tr_b16 a[50:51], v248 offset:6144
    v_mfma_f32_16x16x32_bf16 a[100:103], v[200:203], a[232:235], a[100:103]
    ds_read_b64_tr_b16 a[52:53], v249 offset:4096
    v_mfma_f32_16x16x32_bf16 a[104:107], v[200:203], a[236:239], a[104:107]
    s_waitcnt vmcnt(16)
    ds_read_b64_tr_b16 a[54:55], v249 offset:6144
    v_mfma_f32_16x16x32_bf16 v[236:239], v[204:207], a[240:243], v[236:239]
    buffer_load_dwordx4 v[200:203], v48, s[32:35], s1 offen offset:1024 sc1
    ds_read_b64_tr_b16 a[56:57], v250 offset:4096
    v_mfma_f32_16x16x32_bf16 a[96:99], v[204:207], a[244:247], a[96:99]
    ds_read_b64_tr_b16 a[58:59], v250 offset:6144
    v_mfma_f32_16x16x32_bf16 a[100:103], v[204:207], a[248:251], a[100:103]
    ds_read_b64_tr_b16 a[60:61], v251 offset:4096
    v_mfma_f32_16x16x32_bf16 a[104:107], v[204:207], a[252:255], a[104:107]
    s_waitcnt vmcnt(16)
    s_waitcnt lgkmcnt(14)
    ds_read_b64_tr_b16 a[62:63], v251 offset:6144
    v_mfma_f32_16x16x32_bf16 v[236:239], v[208:211], a[0:3], v[236:239]
    buffer_load_dwordx4 v[204:207], v48, s[32:35], s30 offen offset:1024 sc1
    v_mfma_f32_16x16x32_bf16 a[96:99], v[208:211], a[4:7], a[96:99]
    v_mfma_f32_16x16x32_bf16 a[100:103], v[208:211], a[8:11], a[100:103]
    v_mfma_f32_16x16x32_bf16 a[104:107], v[208:211], a[12:15], a[104:107]
    s_waitcnt vmcnt(16)
    v_mfma_f32_16x16x32_bf16 v[236:239], v[212:215], a[16:19], v[236:239]
    buffer_load_dwordx4 v[208:211], v48, s[32:35], s31 offen offset:1024 sc1
    v_mfma_f32_16x16x32_bf16 a[96:99], v[212:215], a[20:23], a[96:99]
    v_mfma_f32_16x16x32_bf16 a[100:103], v[212:215], a[24:27], a[100:103]
    v_mfma_f32_16x16x32_bf16 a[104:107], v[212:215], a[28:31], a[104:107]
    s_waitcnt vmcnt(16)
    s_waitcnt lgkmcnt(8)
    v_mfma_f32_16x16x32_bf16 v[236:239], v[216:219], a[32:35], v[236:239]
    buffer_load_dwordx4 v[212:215], v48, s[32:35], s40 offen offset:2048 sc1
    v_mfma_f32_16x16x32_bf16 a[96:99], v[216:219], a[36:39], a[96:99]
    v_mfma_f32_16x16x32_bf16 a[100:103], v[216:219], a[40:43], a[100:103]
    v_mfma_f32_16x16x32_bf16 a[104:107], v[216:219], a[44:47], a[104:107]
    s_waitcnt vmcnt(16)
    s_waitcnt lgkmcnt(0)
    v_mfma_f32_16x16x32_bf16 v[236:239], v[220:223], a[48:51], v[236:239]
    buffer_load_dwordx4 v[216:219], v48, s[32:35], s41 offen offset:2048 sc1
    v_mfma_f32_16x16x32_bf16 a[96:99], v[220:223], a[52:55], a[96:99]
    v_mfma_f32_16x16x32_bf16 a[100:103], v[220:223], a[56:59], a[100:103]
    v_mfma_f32_16x16x32_bf16 a[104:107], v[220:223], a[60:63], a[104:107]
    s_waitcnt vmcnt(16)
    v_mfma_f32_16x16x32_bf16 v[240:243], v[224:227], a[128:131], 0
    buffer_load_dwordx4 v[220:223], v48, s[32:35], s42 offen offset:2048 sc1
    v_mfma_f32_16x16x32_bf16 a[108:111], v[224:227], a[132:135], 0
    v_mfma_f32_16x16x32_bf16 a[112:115], v[224:227], a[136:139], 0
    v_mfma_f32_16x16x32_bf16 a[116:119], v[224:227], a[140:143], 0
    s_waitcnt vmcnt(16)
    v_mfma_f32_16x16x32_bf16 v[240:243], v[228:231], a[144:147], v[240:243]
    s_waitcnt vmcnt(12)
    buffer_load_dwordx4 v[224:227], v48, s[32:35], s43 offen offset:2048 sc1
    s_barrier
    v_mfma_f32_16x16x32_bf16 a[108:111], v[228:231], a[148:151], a[108:111]
    s_cmp_eq_u32 s50, 0
    s_cbranch_scc0 L_noyflag
    s_mov_b64 exec, 3
    buffer_store_dwordx2 v[4:5], v47, s[32:35], s16 offen sc1
    s_mov_b64 exec, -1
    s_cmp_eq_u32 s2, 0
    s_cbranch_scc0 L_noyflag
    s_mov_b64 exec, 1
    buffer_store_dwordx2 v[4:5], v47, s[32:35], s2 offen sc1
    s_mov_b64 exec, -1
L_noyflag:
    ds_write_b64 v43, a[96:97] offset:0
    v_mfma_f32_16x16x32_bf16 a[112:115], v[228:231], a[152:155], a[112:115]
    ds_write_b64 v43, a[98:99] offset:8
    v_mfma_f32_16x16x32_bf16 a[116:119], v[228:231], a[156:159], a[116:119]
    v_mfma_f32_16x16x32_bf16 v[240:243], v[232:235], a[160:163], v[240:243]
    buffer_load_dwordx4 v[228:231], v48, s[32:35], s44 offen offset:2048 sc1
    ds_write_b64 v43, a[100:101] offset:1024
    v_mfma_f32_16x16x32_bf16 a[108:111], v[232:235], a[164:167], a[108:111]
    v_mfma_f32_16x16x32_bf16 a[112:115], v[232:235], a[168:171], a[112:115]
    ds_write_b64 v43, a[102:103] offset:1032
    v_mfma_f32_16x16x32_bf16 a[116:119], v[232:235], a[172:175], a[116:119]
    s_waitcnt vmcnt(13)
    v_mfma_f32_16x16x32_bf16 v[240:243], v[176:179], a[176:179], v[240:243]
    buffer_load_dwordx4 v[232:235], v48, s[32:35], s45 offen offset:2048 sc1
    ds_write_b64 v43, a[104:105] offset:2048
    v_mfma_f32_16x16x32_bf16 a[108:111], v[176:179], a[180:183], a[108:111]
    v_mfma_f32_16x16x32_bf16 a[112:115], v[176:179], a[184:187], a[112:115]
    ds_write_b64 v43, a[106:107] offset:2056
    v_mfma_f32_16x16x32_bf16 a[116:119], v[176:179], a[188:191], a[116:119]
    s_waitcnt vmcnt(13)
    v_mfma_f32_16x16x32_bf16 v[240:243], v[180:183], a[192:195], v[240:243]
    buffer_load_dwordx4 v[176:179], v48, s[32:35], s46 offen offset:2048 sc1
    v_mfma_f32_16x16x32_bf16 a[108:111], v[180:183], a[196:199], a[108:111]
    v_mfma_f32_16x16x32_bf16 a[112:115], v[180:183], a[200:203], a[112:115]
    v_mfma_f32_16x16x32_bf16 a[116:119], v[180:183], a[204:207], a[116:119]
    s_waitcnt vmcnt(13)
    v_mfma_f32_16x16x32_bf16 v[240:243], v[184:187], a[208:211], v[240:243]
    buffer_load_dwordx4 v[180:183], v48, s[32:35], s47 offen offset:2048 sc1
    v_mfma_f32_16x16x32_bf16 a[108:111], v[184:187], a[212:215], a[108:111]
    s_waitcnt lgkmcnt(0)
    s_barrier
    ds_read_b128 v[120:123], v40 offset:0
    v_mfma_f32_16x16x32_bf16 a[112:115], v[184:187], a[216:219], a[112:115]
    ds_read_b128 v[124:127], v41 offset:1024
    v_mfma_f32_16x16x32_bf16 a[116:119], v[184:187], a[220:223], a[116:119]
    s_waitcnt vmcnt(13)
    ds_read_b128 v[128:131], v42 offset:2048
    v_mfma_f32_16x16x32_bf16 v[240:243], v[188:191], a[224:227], v[240:243]
    buffer_load_dwordx4 v[184:187], v48, s[32:35], s0 offen offset:2048 sc1
    v_mfma_f32_16x16x32_bf16 a[108:111], v[188:191], a[228:231], a[108:111]
    v_mfma_f32_16x16x32_bf16 a[112:115], v[188:191], a[232:235], a[112:115]
    v_mfma_f32_16x16x32_bf16 a[116:119], v[188:191], a[236:239], a[116:119]
    s_waitcnt vmcnt(13)
    v_mfma_f32_16x16x32_bf16 v[240:243], v[192:195], a[240:243], v[240:243]
    buffer_load_dwordx4 v[188:191], v48, s[32:35], s1 offen offset:2048 sc1
    v_mfma_f32_16x16x32_bf16 a[108:111], v[192:195], a[244:247], a[108:111]
    v_mfma_f32_16x16x32_bf16 a[112:115], v[192:195], a[248:251], a[112:115]
    s_waitcnt lgkmcnt(0)
    v_add_f32 v236, v236, v120
    v_add_f32 v237, v237, v121
    v_mfma_f32_16x16x32_bf16 a[116:119], v[192:195], a[252:255], a[116:119]
    s_waitcnt vmcnt(13)
    v_add_f32 v238, v238, v122
    v_add_f32 v239, v239, v123
    v_mfma_f32_16x16x32_bf16 v[240:243], v[196:199], a[0:3], v[240:243]
    buffer_load_dwordx4 v[192:195], v48, s[32:35], s30 offen offset:2048 sc1
    v_add_f32 v236, v236, v124
    v_mfma_f32_16x16x32_bf16 a[108:111], v[196:199], a[4:7], a[108:111]
    v_add_f32 v237, v237, v125
    v_add_f32 v238, v238, v126
    v_mfma_f32_16x16x32_bf16 a[112:115], v[196:199], a[8:11], a[112:115]
    v_add_f32 v239, v239, v127
    v_add_f32 v236, v236, v128
    v_mfma_f32_16x16x32_bf16 a[116:119], v[196:199], a[12:15], a[116:119]
    s_waitcnt vmcnt(13)
    v_add_f32 v237, v237, v129
    v_add_f32 v238, v238, v130
    v_mfma_f32_16x16x32_bf16 v[240:243], v[200:203], a[16:19], v[240:243]
    buffer_load_dwordx4 v[196:199], v48, s[32:35], s31 offen offset:2048 sc1
    v_add_f32 v239, v239, v131
    v_mfma_f32_16x16x32_bf16 a[108:111], v[200:203], a[20:23], a[108:111]
    v_fma_f32 v236, v236, v58, v60
    v_fma_f32 v237, v237, v58, v60
    v_mfma_f32_16x16x32_bf16 a[112:115], v[200:203], a[24:27], a[112:115]
    v_fma_f32 v238, v238, v58, v60
    v_fma_f32 v239, v239, v58, v60
    v_mfma_f32_16x16x32_bf16 a[116:119], v[200:203], a[28:31], a[116:119]
    s_waitcnt vmcnt(13)
    v_mfma_f32_16x16x32_bf16 v[240:243], v[204:207], a[32:35], v[240:243]
    buffer_load_dwordx4 v[200:203], v48, s[32:35], s40 offen offset:3072 sc1
    v_mfma_f32_16x16x32_bf16 a[108:111], v[204:207], a[36:39], a[108:111]
    v_mfma_f32_16x16x32_bf16 a[112:115], v[204:207], a[40:43], a[112:115]
    v_mfma_f32_16x16x32_bf16 a[116:119], v[204:207], a[44:47], a[116:119]
    s_waitcnt vmcnt(13)
    v_mfma_f32_16x16x32_bf16 v[240:243], v[208:211], a[48:51], v[240:243]
    buffer_load_dwordx4 v[204:207], v48, s[32:35], s41 offen offset:3072 sc1
    v_mfma_f32_16x16x32_bf16 a[108:111], v[208:211], a[52:55], a[108:111]
    v_mfma_f32_16x16x32_bf16 a[112:115], v[208:211], a[56:59], a[112:115]
    v_mfma_f32_16x16x32_bf16 a[116:119], v[208:211], a[60:63], a[116:119]
    s_waitcnt vmcnt(13)
    v_mfma_f32_16x16x32_bf16 v[244:247], v[212:215], a[128:131], 0
    buffer_load_dwordx4 v[208:211], v48, s[32:35], s42 offen offset:3072 sc1
    v_mfma_f32_16x16x32_bf16 a[96:99], v[212:215], a[132:135], 0
    v_mfma_f32_16x16x32_bf16 a[100:103], v[212:215], a[136:139], 0
    v_mfma_f32_16x16x32_bf16 a[104:107], v[212:215], a[140:143], 0
    s_waitcnt vmcnt(13)
    v_mfma_f32_16x16x32_bf16 v[244:247], v[216:219], a[144:147], v[244:247]
    buffer_load_dwordx4 v[212:215], v48, s[32:35], s43 offen offset:3072 sc1
    ds_write_b64 v43, a[108:109] offset:3072
    v_mfma_f32_16x16x32_bf16 a[96:99], v[216:219], a[148:151], a[96:99]
    ds_write_b64 v43, a[110:111] offset:3080
    v_mfma_f32_16x16x32_bf16 a[100:103], v[216:219], a[152:155], a[100:103]
    v_mfma_f32_16x16x32_bf16 a[104:107], v[216:219], a[156:159], a[104:107]
    s_waitcnt vmcnt(13)
    ds_write_b64 v43, a[112:113] offset:4096
    v_mfma_f32_16x16x32_bf16 v[244:247], v[220:223], a[160:163], v[244:247]
    buffer_load_dwordx4 v[216:219], v48, s[32:35], s44 offen offset:3072 sc1
    v_mfma_f32_16x16x32_bf16 a[96:99], v[220:223], a[164:167], a[96:99]
    ds_write_b64 v43, a[114:115] offset:4104
    v_mfma_f32_16x16x32_bf16 a[100:103], v[220:223], a[168:171], a[100:103]
    v_mfma_f32_16x16x32_bf16 a[104:107], v[220:223], a[172:175], a[104:107]
    s_waitcnt vmcnt(13)
    ds_write_b64 v43, a[116:117] offset:5120
    v_mfma_f32_16x16x32_bf16 v[244:247], v[224:227], a[176:179], v[244:247]
    buffer_load_dwordx4 v[220:223], v48, s[32:35], s45 offen offset:3072 sc1
    v_mfma_f32_16x16x32_bf16 a[96:99], v[224:227], a[180:183], a[96:99]
    ds_write_b64 v43, a[118:119] offset:5128
    v_mfma_f32_16x16x32_bf16 a[100:103], v[224:227], a[184:187], a[100:103]
    v_mfma_f32_16x16x32_bf16 a[104:107], v[224:227], a[188:191], a[104:107]
    s_waitcnt vmcnt(13)
    v_mfma_f32_16x16x32_bf16 v[244:247], v[228:231], a[192:195], v[244:247]
    buffer_load_dwordx4 v[224:227], v48, s[32:35], s46 offen offset:3072 sc1
    v_mfma_f32_16x16x32_bf16 a[96:99], v[228:231], a[196:199], a[96:99]
    v_mfma_f32_16x16x32_bf16 a[100:103], v[228:231], a[200:203], a[100:103]
    v_mfma_f32_16x16x32_bf16 a[104:107], v[228:231], a[204:207], a[104:107]
    s_waitcnt vmcnt(13)
    v_mfma_f32_16x16x32_bf16 v[244:247], v[232:235], a[208:211], v[244:247]
    s_waitcnt lgkmcnt(0)
    buffer_load_dwordx4 v[228:231], v48, s[32:35], s47 offen offset:3072 sc1
    s_barrier
    v_mfma_f32_16x16x32_bf16 a[96:99], v[232:235], a[212:215], a[96:99]
    ds_read_b128 v[120:123], v40 offset:3072
    v_mfma_f32_16x16x32_bf16 a[100:103], v[232:235], a[216:219], a[100:103]
    ds_read_b128 v[124:127], v41 offset:4096
    v_mfma_f32_16x16x32_bf16 a[104:107], v[232:235], a[220:223], a[104:107]
    s_waitcnt vmcnt(13)
    ds_read_b128 v[128:131], v42 offset:5120
    v_mfma_f32_16x16x32_bf16 v[244:247], v[176:179], a[224:227], v[244:247]
    buffer_load_dwordx4 v[232:235], v48, s[32:35], s0 offen offset:3072 sc1
    v_mfma_f32_16x16x32_bf16 a[96:99], v[176:179], a[228:231], a[96:99]
    v_mfma_f32_16x16x32_bf16 a[100:103], v[176:179], a[232:235], a[100:103]
    v_mfma_f32_16x16x32_bf16 a[104:107], v[176:179], a[236:239], a[104:107]
    s_waitcnt vmcnt(13)
    v_mfma_f32_16x16x32_bf16 v[244:247], v[180:183], a[240:243], v[244:247]
    buffer_load_dwordx4 v[176:179], v48, s[32:35], s1 offen offset:3072 sc1
    v_mfma_f32_16x16x32_bf16 a[96:99], v[180:183], a[244:247], a[96:99]
    v_mfma_f32_16x16x32_bf16 a[100:103], v[180:183], a[248:251], a[100:103]
    s_waitcnt lgkmcnt(0)
    v_add_f32 v240, v240, v120
    v_add_f32 v241, v241, v121
    v_mfma_f32_16x16x32_bf16 a[104:107], v[180:183], a[252:255], a[104:107]
    s_waitcnt vmcnt(13)
    v_add_f32 v242, v242, v122
    v_add_f32 v243, v243, v123
    v_mfma_f32_16x16x32_bf16 v[244:247], v[184:187], a[0:3], v[244:247]
    buffer_load_dwordx4 v[180:183], v48, s[32:35], s30 offen offset:3072 sc1
    v_add_f32 v240, v240, v124
    v_mfma_f32_16x16x32_bf16 a[96:99], v[184:187], a[4:7], a[96:99]
    v_add_f32 v241, v241, v125
    v_add_f32 v242, v242, v126
    v_mfma_f32_16x16x32_bf16 a[100:103], v[184:187], a[8:11], a[100:103]
    v_add_f32 v243, v243, v127
    v_add_f32 v240, v240, v128
    v_mfma_f32_16x16x32_bf16 a[104:107], v[184:187], a[12:15], a[104:107]
    s_waitcnt vmcnt(13)
    v_add_f32 v241, v241, v129
    v_add_f32 v242, v242, v130
    v_mfma_f32_16x16x32_bf16 v[244:247], v[188:191], a[16:19], v[244:247]
    buffer_load_dwordx4 v[184:187], v48, s[32:35], s31 offen offset:3072 sc1
    v_add_f32 v243, v243, v131
    v_mfma_f32_16x16x32_bf16 a[96:99], v[188:191], a[20:23], a[96:99]
    v_fma_f32 v240, v240, v58, v60
    v_fma_f32 v241, v241, v58, v60
    v_mfma_f32_16x16x32_bf16 a[100:103], v[188:191], a[24:27], a[100:103]
    v_fma_f32 v242, v242, v58, v60
    v_fma_f32 v243, v243, v58, v60
    v_mfma_f32_16x16x32_bf16 a[104:107], v[188:191], a[28:31], a[104:107]
    s_waitcnt vmcnt(13)
    v_mfma_f32_16x16x32_bf16 v[244:247], v[192:195], a[32:35], v[244:247]
    buffer_load_dwordx4 v[188:191], v49, s[32:35], s40 offen offset:0 sc1
    v_mfma_f32_16x16x32_bf16 a[96:99], v[192:195], a[36:39], a[96:99]
    v_mfma_f32_16x16x32_bf16 a[100:103], v[192:195], a[40:43], a[100:103]
    v_mfma_f32_16x16x32_bf16 a[104:107], v[192:195], a[44:47], a[104:107]
    s_waitcnt vmcnt(13)
    v_mfma_f32_16x16x32_bf16 v[244:247], v[196:199], a[48:51], v[244:247]
    buffer_load_dwordx4 v[192:195], v49, s[32:35], s41 offen offset:0 sc1
    v_mfma_f32_16x16x32_bf16 a[96:99], v[196:199], a[52:55], a[96:99]
    v_mfma_f32_16x16x32_bf16 a[100:103], v[196:199], a[56:59], a[100:103]
    v_mfma_f32_16x16x32_bf16 a[104:107], v[196:199], a[60:63], a[104:107]
    s_waitcnt vmcnt(13)
    v_mfma_f32_16x16x32_bf16 v[248:251], v[200:203], a[128:131], 0
    buffer_load_dwordx4 v[196:199], v49, s[32:35], s42 offen offset:0 sc1
    v_mfma_f32_16x16x32_bf16 a[108:111], v[200:203], a[132:135], 0
    v_mfma_f32_16x16x32_bf16 a[112:115], v[200:203], a[136:139], 0
    v_mfma_f32_16x16x32_bf16 a[116:119], v[200:203], a[140:143], 0
    s_waitcnt vmcnt(13)
    v_mfma_f32_16x16x32_bf16 v[248:251], v[204:207], a[144:147], v[248:251]
    buffer_load_dwordx4 v[200:203], v49, s[32:35], s43 offen offset:0 sc1
    ds_write_b64 v43, a[96:97] offset:6144
    v_mfma_f32_16x16x32_bf16 a[108:111], v[204:207], a[148:151], a[108:111]
    ds_write_b64 v43, a[98:99] offset:6152
    v_mfma_f32_16x16x32_bf16 a[112:115], v[204:207], a[152:155], a[112:115]
    v_mfma_f32_16x16x32_bf16 a[116:119], v[204:207], a[156:159], a[116:119]
    s_waitcnt vmcnt(13)
    ds_write_b64 v43, a[100:101] offset:7168
    v_mfma_f32_16x16x32_bf16 v[248:251], v[208:211], a[160:163], v[248:251]
    buffer_load_dwordx4 v[204:207], v49, s[32:35], s44 offen offset:0 sc1
    v_mfma_f32_16x16x32_bf16 a[108:111], v[208:211], a[164:167], a[108:111]
    ds_write_b64 v43, a[102:103] offset:7176
    v_mfma_f32_16x16x32_bf16 a[112:115], v[208:211], a[168:171], a[112:115]
    v_mfma_f32_16x16x32_bf16 a[116:119], v[208:211], a[172:175], a[116:119]
    s_waitcnt vmcnt(13)
    ds_write_b64 v43, a[104:105] offset:8192
    v_mfma_f32_16x16x32_bf16 v[248:251], v[212:215], a[176:179], v[248:251]
    buffer_load_dwordx4 v[208:211], v49, s[32:35], s45 offen offset:0 sc1
    v_mfma_f32_16x16x32_bf16 a[108:111], v[212:215], a[180:183], a[108:111]
    ds_write_b64 v43, a[106:107] offset:8200
    v_mfma_f32_16x16x32_bf16 a[112:115], v[212:215], a[184:187], a[112:115]
    v_mfma_f32_16x16x32_bf16 a[116:119], v[212:215], a[188:191], a[116:119]
    s_waitcnt vmcnt(13)
    v_mfma_f32_16x16x32_bf16 v[248:251], v[216:219], a[192:195], v[248:251]
    buffer_load_dwordx4 v[212:215], v49, s[32:35], s46 offen offset:0 sc1
    v_mfma_f32_16x16x32_bf16 a[108:111], v[216:219], a[196:199], a[108:111]
    v_mfma_f32_16x16x32_bf16 a[112:115], v[216:219], a[200:203], a[112:115]
    v_mfma_f32_16x16x32_bf16 a[116:119], v[216:219], a[204:207], a[116:119]
    s_waitcnt vmcnt(13)
    v_mfma_f32_16x16x32_bf16 v[248:251], v[220:223], a[208:211], v[248:251]
    s_waitcnt lgkmcnt(0)
    buffer_load_dwordx4 v[216:219], v49, s[32:35], s47 offen offset:0 sc1
    s_barrier
    v_mfma_f32_16x16x32_bf16 a[108:111], v[220:223], a[212:215], a[108:111]
    ds_read_b128 v[120:123], v40 offset:6144
    v_mfma_f32_16x16x32_bf16 a[112:115], v[220:223], a[216:219], a[112:115]
    ds_read_b128 v[124:127], v41 offset:7168
    v_mfma_f32_16x16x32_bf16 a[116:119], v[220:223], a[220:223], a[116:119]
    s_waitcnt vmcnt(13)
    ds_read_b128 v[128:131], v42 offset:8192
    v_mfma_f32_16x16x32_bf16 v[248:251], v[224:227], a[224:227], v[248:251]
    buffer_load_dwordx4 v[220:223], v49, s[32:35], s0 offen offset:0 sc1
    v_mfma_f32_16x16x32_bf16 a[108:111], v[224:227], a[228:231], a[108:111]
    v_mfma_f32_16x16x32_bf16 a[112:115], v[224:227], a[232:235], a[112:115]
    v_mfma_f32_16x16x32_bf16 a[116:119], v[224:227], a[236:239], a[116:119]
    s_waitcnt vmcnt(13)
    v_mfma_f32_16x16x32_bf16 v[248:251], v[228:231], a[240:243], v[248:251]
    buffer_load_dwordx4 v[224:227], v49, s[32:35], s1 offen offset:0 sc1
    v_mfma_f32_16x16x32_bf16 a[108:111], v[228:231], a[244:247], a[108:111]
    v_mfma_f32_16x16x32_bf16 a[112:115], v[228:231], a[248:251], a[112:115]
    s_waitcnt lgkmcnt(0)
    v_add_f32 v244, v244, v120
    v_add_f32 v245, v245, v121
    v_mfma_f32_16x16x32_bf16 a[116:119], v[228:231], a[252:255], a[116:119]
    s_waitcnt vmcnt(13)
    v_add_f32 v246, v246, v122
    v_add_f32 v247, v247, v123
    v_mfma_f32_16x16x32_bf16 v[248:251], v[232:235], a[0:3], v[248:251]
    buffer_load_dwordx4 v[228:231], v49, s[32:35], s30 offen offset:0 sc1
    v_add_f32 v244, v244, v124
    v_mfma_f32_16x16x32_bf16 a[108:111], v[232:235], a[4:7], a[108:111]
    v_add_f32 v245, v245, v125
    v_add_f32 v246, v246, v126
    v_mfma_f32_16x16x32_bf16 a[112:115], v[232:235], a[8:11], a[112:115]
    buffer_load_dwordx2 v[36:37], v38, s[32:35], 0 offen sc1
    v_add_f32 v247, v247, v127
    v_mfma_f32_16x16x32_bf16 a[116:119], v[232:235], a[12:15], a[116:119]
    s_waitcnt vmcnt(14)
    v_add_f32 v244, v244, v128
    v_add_f32 v245, v245, v129
    v_mfma_f32_16x16x32_bf16 v[248:251], v[176:179], a[16:19], v[248:251]
    buffer_load_dwordx4 v[232:235], v49, s[32:35], s31 offen offset:0 sc1
    v_add_f32 v246, v246, v130
    v_mfma_f32_16x16x32_bf16 a[108:111], v[176:179], a[20:23], a[108:111]
    v_add_f32 v247, v247, v131
    v_fma_f32 v244, v244, v58, v60
    v_mfma_f32_16x16x32_bf16 a[112:115], v[176:179], a[24:27], a[112:115]
    v_fma_f32 v245, v245, v58, v60
    v_fma_f32 v246, v246, v58, v60
    v_mfma_f32_16x16x32_bf16 a[116:119], v[176:179], a[28:31], a[116:119]
    s_waitcnt vmcnt(14)
    v_fma_f32 v247, v247, v58, v60
    v_mfma_f32_16x16x32_bf16 v[248:251], v[180:183], a[32:35], v[248:251]
    v_mfma_f32_16x16x32_bf16 a[108:111], v[180:183], a[36:39], a[108:111]
    v_mfma_f32_16x16x32_bf16 a[112:115], v[180:183], a[40:43], a[112:115]
    v_mfma_f32_16x16x32_bf16 a[116:119], v[180:183], a[44:47], a[116:119]
    s_waitcnt vmcnt(13)
    v_mfma_f32_16x16x32_bf16 v[248:251], v[184:187], a[48:51], v[248:251]
    v_mfma_f32_16x16x32_bf16 a[108:111], v[184:187], a[52:55], a[108:111]
    v_mfma_f32_16x16x32_bf16 a[112:115], v[184:187], a[56:59], a[112:115]
    v_mfma_f32_16x16x32_bf16 a[116:119], v[184:187], a[60:63], a[116:119]
    s_waitcnt vmcnt(12)
    v_mfma_f32_16x16x32_bf16 v[252:255], v[188:191], a[128:131], 0
    v_mfma_f32_16x16x32_bf16 a[96:99], v[188:191], a[132:135], 0
    v_mfma_f32_16x16x32_bf16 a[100:103], v[188:191], a[136:139], 0
    s_add_u32 m0, s59, 20480
    s_nop 0
    buffer_load_dwordx4 v16, s[60:63], 0 offen lds
    v_mfma_f32_16x16x32_bf16 a[104:107], v[188:191], a[140:143], 0
    s_waitcnt vmcnt(12)
    v_mfma_f32_16x16x32_bf16 v[252:255], v[192:195], a[144:147], v[252:255]
    ds_write_b64 v43, a[108:109] offset:9216
    v_mfma_f32_16x16x32_bf16 a[96:99], v[192:195], a[148:151], a[96:99]
    ds_write_b64 v43, a[110:111] offset:9224
    v_mfma_f32_16x16x32_bf16 a[100:103], v[192:195], a[152:155], a[100:103]
    s_add_u32 m0, s59, 21504
    s_nop 0
    buffer_load_dwordx4 v17, s[60:63], 0 offen lds
    v_mfma_f32_16x16x32_bf16 a[104:107], v[192:195], a[156:159], a[104:107]
    s_waitcnt vmcnt(12)
    ds_write_b64 v43, a[112:113] offset:10240
    v_mfma_f32_16x16x32_bf16 v[252:255], v[196:199], a[160:163], v[252:255]
    v_mfma_f32_16x16x32_bf16 a[96:99], v[196:199], a[164:167], a[96:99]
    ds_write_b64 v43, a[114:115] offset:10248
    v_mfma_f32_16x16x32_bf16 a[100:103], v[196:199], a[168:171], a[100:103]
    s_add_u32 m0, s59, 22528
    s_nop 0
    buffer_load_dwordx4 v18, s[60:63], 0 offen lds
    v_mfma_f32_16x16x32_bf16 a[104:107], v[196:199], a[172:175], a[104:107]
    s_waitcnt vmcnt(12)
    ds_write_b64 v43, a[116:117] offset:11264
    v_mfma_f32_16x16x32_bf16 v[252:255], v[200:203], a[176:179], v[252:255]
    v_mfma_f32_16x16x32_bf16 a[96:99], v[200:203], a[180:183], a[96:99]
    ds_write_b64 v43, a[118:119] offset:11272
    v_mfma_f32_16x16x32_bf16 a[100:103], v[200:203], a[184:187], a[100:103]
    v_mfma_f32_16x16x32_bf16 a[104:107], v[200:203], a[188:191], a[104:107]
    s_waitcnt vmcnt(11)
    v_mfma_f32_16x16x32_bf16 v[252:255], v[204:207], a[192:195], v[252:255]
    v_mfma_f32_16x16x32_bf16 a[96:99], v[204:207], a[196:199], a[96:99]
    v_mfma_f32_16x16x32_bf16 a[100:103], v[204:207], a[200:203], a[100:103]
    v_mfma_f32_16x16x32_bf16 a[104:107], v[204:207], a[204:207], a[104:107]
    s_waitcnt vmcnt(10)
    v_mfma_f32_16x16x32_bf16 v[252:255], v[208:211], a[208:211], v[252:255]
    s_waitcnt lgkmcnt(0)
    s_barrier
    ds_read_b128 v[120:123], v40 offset:9216
    v_mfma_f32_16x16x32_bf16 a[96:99], v[208:211], a[212:215], a[96:99]
    ds_read_b128 v[124:127], v41 offset:10240
    v_mfma_f32_16x16x32_bf16 a[100:103], v[208:211], a[216:219], a[100:103]
    ds_read_b128 v[128:131], v42 offset:11264
    v_mfma_f32_16x16x32_bf16 a[104:107], v[208:211], a[220:223], a[104:107]
    s_waitcnt vmcnt(9)
    s_waitcnt vmcnt(4)
    v_cmp_ne_u64 vcc, s[48:49], v[36:37]
    s_cbranch_vccz L_polly_ok
    s_mov_b32 s3, 0
L_polly:
    s_mov_b64 exec, vcc
    buffer_load_dwordx2 v[36:37], v38, s[32:35], 0 offen sc1
    s_waitcnt vmcnt(0)
    v_cmp_ne_u64 vcc, s[48:49], v[36:37]
    s_add_u32 s3, s3, 1
    s_cbranch_vccz L_polly_out
    s_cmp_lt_u32 s3, 200000
    s_cbranch_scc1 L_polly
L_polly_out:
    s_mov_b64 exec, -1
L_polly_ok:
    v_mfma_f32_16x16x32_bf16 v[252:255], v[212:215], a[224:227], v[252:255]
    v_mfma_f32_16x16x32_bf16 a[96:99], v[212:215], a[228:231], a[96:99]
    v_mfma_f32_16x16x32_bf16 a[100:103], v[212:215], a[232:235], a[100:103]
    s_add_u32 m0, s59, 16384
    s_nop 0
    buffer_load_dwordx4 v32, s[32:35], 0 offen sc1 lds
    v_mfma_f32_16x16x32_bf16 a[104:107], v[212:215], a[236:239], a[104:107]
    v_mfma_f32_16x16x32_bf16 v[252:255], v[216:219], a[240:243], v[252:255]
    v_mfma_f32_16x16x32_bf16 a[96:99], v[216:219], a[244:247], a[96:99]
    s_waitcnt lgkmcnt(0)
    v_add_f32 v248, v248, v120
    v_add_f32 v249, v249, v121
    v_mfma_f32_16x16x32_bf16 a[100:103], v[216:219], a[248:251], a[100:103]
    s_add_u32 m0, s59, 17408
    s_nop 0
    buffer_load_dwordx4 v33, s[32:35], 0 offen sc1 lds
    v_add_f32 v250, v250, v122
    v_mfma_f32_16x16x32_bf16 a[104:107], v[216:219], a[252:255], a[104:107]
    v_add_f32 v251, v251, v123
    v_add_f32 v248, v248, v124
    v_mfma_f32_16x16x32_bf16 v[252:255], v[220:223], a[0:3], v[252:255]
    v_add_f32 v249, v249, v125
    v_add_f32 v250, v250, v126
    v_mfma_f32_16x16x32_bf16 a[96:99], v[220:223], a[4:7], a[96:99]
    v_add_f32 v251, v251, v127
    v_add_f32 v248, v248, v128
    v_mfma_f32_16x16x32_bf16 a[100:103], v[220:223], a[8:11], a[100:103]
    s_add_u32 m0, s59, 18432
    s_nop 0
    buffer_load_dwordx4 v34, s[32:35], 0 offen sc1 lds
    v_add_f32 v249, v249, v129
    v_mfma_f32_16x16x32_bf16 a[104:107], v[220:223], a[12:15], a[104:107]
    v_add_f32 v250, v250, v130
    v_add_f32 v251, v251, v131
    v_mfma_f32_16x16x32_bf16 v[252:255], v[224:227], a[16:19], v[252:255]
    v_fma_f32 v248, v248, v58, v60
    v_fma_f32 v249, v249, v58, v60
    v_mfma_f32_16x16x32_bf16 a[96:99], v[224:227], a[20:23], a[96:99]
    v_fma_f32 v250, v250, v58, v60
    v_fma_f32 v251, v251, v58, v60
    v_mfma_f32_16x16x32_bf16 a[100:103], v[224:227], a[24:27], a[100:103]
    v_mfma_f32_16x16x32_bf16 a[104:107], v[224:227], a[28:31], a[104:107]
    v_mfma_f32_16x16x32_bf16 v[252:255], v[228:231], a[32:35], v[252:255]
    v_mfma_f32_16x16x32_bf16 a[96:99], v[228:231], a[36:39], a[96:99]
    v_mfma_f32_16x16x32_bf16 a[100:103], v[228:231], a[40:43], a[100:103]
    v_mfma_f32_16x16x32_bf16 a[104:107], v[228:231], a[44:47], a[104:107]
    s_waitcnt vmcnt(6)
    v_mfma_f32_16x16x32_bf16 v[252:255], v[232:235], a[48:51], v[252:255]
    v_mfma_f32_16x16x32_bf16 a[96:99], v[232:235], a[52:55], a[96:99]
    v_mfma_f32_16x16x32_bf16 a[100:103], v[232:235], a[56:59], a[100:103]
    v_mfma_f32_16x16x32_bf16 a[104:107], v[232:235], a[60:63], a[104:107]
    s_nop 5
    ds_write_b128 v43, a[96:99] offset:12288
    ds_write_b128 v43, a[100:103] offset:13312
    ds_write_b128 v43, a[104:107] offset:14336
    s_waitcnt vmcnt(3)
    ds_read_b64 v[154:155], v19 offset:0
    ds_read_b64 v[156:157], v20 offset:0
    ds_read_b64 v[158:159], v21 offset:0
    ds_read_b64 v[160:161], v22 offset:0
    ds_read_b64 v[162:163], v23 offset:2048
    s_waitcnt lgkmcnt(4)
    v_lshlrev_b32 v64, 16, v154
    v_and_b32 v65, 0xffff0000, v154
    v_lshlrev_b32 v66, 16, v155
    v_and_b32 v67, 0xffff0000, v155
    v_pk_mul_f32 v[64:65], v[64:65], v[56:57] op_sel_hi:[1,0]
    v_pk_mul_f32 v[66:67], v[66:67], v[56:57] op_sel_hi:[1,0]
    s_waitcnt lgkmcnt(3)
    v_lshlrev_b32 v68, 16, v156
    v_and_b32 v69, 0xffff0000, v156
    v_lshlrev_b32 v70, 16, v157
    v_and_b32 v71, 0xffff0000, v157
    v_pk_mul_f32 v[68:69], v[68:69], v[56:57] op_sel_hi:[1,0]
    v_pk_mul_f32 v[70:71], v[70:71], v[56:57] op_sel_hi:[1,0]
    s_waitcnt lgkmcnt(2)
    v_lshlrev_b32 v72, 16, v158
    v_and_b32 v73, 0xffff0000, v158
    v_lshlrev_b32 v74, 16, v159
    v_and_b32 v75, 0xffff0000, v159
    v_pk_mul_f32 v[72:73], v[72:73], v[56:57] op_sel_hi:[1,0]
    v_pk_mul_f32 v[74:75], v[74:75], v[56:57] op_sel_hi:[1,0]
    s_waitcnt lgkmcnt(1)
    v_lshlrev_b32 v76, 16, v160
    v_and_b32 v77, 0xffff0000, v160
    v_lshlrev_b32 v78, 16, v161
    v_and_b32 v79, 0xffff0000, v161
    v_pk_mul_f32 v[76:77], v[76:77], v[56:57] op_sel_hi:[1,0]
    v_pk_mul_f32 v[78:79], v[78:79], v[56:57] op_sel_hi:[1,0]
    s_waitcnt lgkmcnt(0)
    v_lshlrev_b32 v80, 16, v162
    v_and_b32 v81, 0xffff0000, v162
    v_lshlrev_b32 v82, 16, v163
    v_and_b32 v83, 0xffff0000, v163
    v_pk_mul_f32 v[80:81], v[80:81], v[56:57] op_sel_hi:[1,0]
    v_pk_mul_f32 v[82:83], v[82:83], v[56:57] op_sel_hi:[1,0]
    s_waitcnt vmcnt(0)
    s_waitcnt lgkmcnt(0)
    s_barrier
    ds_read_b64_tr_b16 v[144:145], v35 offset:0
    ds_read_b64_tr_b16 v[146:147], v35 offset:49152
    ds_read_b64_tr_b16 v[148:149], v35 offset:1024
    ds_read_b64_tr_b16 v[150:151], v35 offset:50176
    ds_read_b64_tr_b16 v[152:153], v35 offset:2048
    ds_read_b128 v[120:123], v40 offset:12288
    ds_read_b128 v[124:127], v41 offset:13312
    ds_read_b128 v[128:131], v42 offset:14336
    s_waitcnt lgkmcnt(7)
    v_lshlrev_b32 v96, 16, v144
    v_and_b32 v97, 0xffff0000, v144
    v_lshlrev_b32 v98, 16, v145
    v_and_b32 v99, 0xffff0000, v145
    v_pk_fma_f32 v[236:237], v[64:65], v[96:97], v[236:237]
    v_pk_fma_f32 v[238:239], v[66:67], v[98:99], v[238:239]
    v_cvt_pk_bf16_f32 v88, v236, v237
    v_cvt_pk_bf16_f32 v89, v238, v239
    ds_write_b64 v19, v[88:89] offset:0
    s_waitcnt lgkmcnt(7)
    v_lshlrev_b32 v100, 16, v146
    v_and_b32 v101, 0xffff0000, v146
    v_lshlrev_b32 v102, 16, v147
    v_and_b32 v103, 0xffff0000, v147
    v_pk_fma_f32 v[240:241], v[68:69], v[100:101], v[240:241]
    v_pk_fma_f32 v[242:243], v[70:71], v[102:103], v[242:243]
    v_cvt_pk_bf16_f32 v90, v240, v241
    v_cvt_pk_bf16_f32 v91, v242, v243
    ds_write_b64 v20, v[90:91] offset:0
    s_waitcnt lgkmcnt(7)
    v_lshlrev_b32 v96, 16, v148
    v_and_b32 v97, 0xffff0000, v148
    v_lshlrev_b32 v98, 16, v149
    v_and_b32 v99, 0xffff0000, v149
    v_pk_fma_f32 v[244:245], v[72:73], v[96:97], v[244:245]
    v_pk_fma_f32 v[246:247], v[74:75], v[98:99], v[246:247]
    v_cvt_pk_bf16_f32 v88, v244, v245
    v_cvt_pk_bf16_f32 v89, v246, v247
    ds_write_b64 v21, v[88:89] offset:0
    s_waitcnt lgkmcnt(7)
    v_lshlrev_b32 v100, 16, v150
    v_and_b32 v101, 0xffff0000, v150
    v_lshlrev_b32 v102, 16, v151
    v_and_b32 v103, 0xffff0000, v151
    v_pk_fma_f32 v[248:249], v[76:77], v[100:101], v[248:249]
    v_pk_fma_f32 v[250:251], v[78:79], v[102:103], v[250:251]
    v_cvt_pk_bf16_f32 v90, v248, v249
    v_cvt_pk_bf16_f32 v91, v250, v251
    ds_write_b64 v22, v[90:91] offset:0
    ds_read_b128 v[104:107], v43 offset:20480
    ds_read_b128 v[108:111], v43 offset:21504
    s_waitcnt lgkmcnt(6)
    v_pk_add_f32 v[252:253], v[252:253], v[120:121]
    v_pk_add_f32 v[254:255], v[254:255], v[122:123]
    v_pk_add_f32 v[252:253], v[252:253], v[124:125]
    v_pk_add_f32 v[254:255], v[254:255], v[126:127]
    v_pk_add_f32 v[252:253], v[252:253], v[128:129]
    v_pk_add_f32 v[254:255], v[254:255], v[130:131]
    v_pk_fma_f32 v[252:253], v[252:253], v[58:59], v[60:61] op_sel_hi:[1,0,0]
    v_pk_fma_f32 v[254:255], v[254:255], v[58:59], v[60:61] op_sel_hi:[1,0,0]
    v_lshlrev_b32 v96, 16, v152
    v_and_b32 v97, 0xffff0000, v152
    v_lshlrev_b32 v98, 16, v153
    v_and_b32 v99, 0xffff0000, v153
    v_pk_fma_f32 v[252:253], v[80:81], v[96:97], v[252:253]
    v_pk_fma_f32 v[254:255], v[82:83], v[98:99], v[254:255]
    v_cvt_pk_bf16_f32 v88, v252, v253
    v_cvt_pk_bf16_f32 v89, v254, v255
    ds_write_b64 v23, v[88:89] offset:2048
    ds_read_b128 v[112:115], v43 offset:22528
    s_waitcnt lgkmcnt(3)
    buffer_store_dwordx4 v[104:107], v16, s[64:67], 0 offen
    s_waitcnt lgkmcnt(2)
    buffer_store_dwordx4 v[108:111], v17, s[64:67], 0 offen
    s_waitcnt lgkmcnt(0)
    buffer_store_dwordx4 v[112:115], v18, s[64:67], 0 offen
L_end:
    s_endpgm
.section .rodata,"a"
.p2align 6
.amdhsa_kernel gated_mix__ssm_conv_h3__mixer_token_mlp__prompt_kernel
  .amdhsa_next_free_vgpr 512
  .amdhsa_next_free_sgpr 102
  .amdhsa_accum_offset 256
  .amdhsa_group_segment_fixed_size 0
  .amdhsa_kernarg_size 120
  .amdhsa_user_sgpr_count 2
  .amdhsa_user_sgpr_kernarg_segment_ptr 1
  .amdhsa_system_sgpr_workgroup_id_x 1
.end_amdhsa_kernel
```
